```python
import torch

def _softmax(x, axis=-1):
    return torch.softmax(x, dim=axis)
def _gelu(x):
    return torch.nn.functional.gelu(x, approximate="tanh")
def _silu(x):
    return torch.nn.functional.silu(x)
def _sigmoid(x):
    return torch.sigmoid(x)
def _layernorm(x, axis=-1, eps=1e-5):
    m = x.mean(dim=axis, keepdim=True)
    v = x.var(dim=axis, keepdim=True, unbiased=False)
    return (x - m) / torch.sqrt(v + eps)
def _scatter_add(tgt, idx, src, axis=0):
    return tgt.clone().index_add_(axis, idx, src)
def _segment_sum(src, seg, n):
    out = torch.zeros((n,) + src.shape[1:], dtype=src.dtype)
    return out.index_add_(0, seg, src)
def _pad(x, pw):
    flat = tuple(v for pair in reversed(pw) for v in pair)
    return torch.nn.functional.pad(x, flat)

kernel_name = 'interleave_layers__sliding_block_cached__mixer_channel_mlp__decode'

def setup_inputs():

    _w = (lambda a: (lambda t: t.to(torch.bfloat16) if t.is_floating_point() else t)(torch.as_tensor(a)))
    def _A_setup():
        B, Sq, D = 8, 1, 1024
        Hq, Hkv, Sk, Dh = 32, 4, 4096, 128
        assert Hq % Hkv == 0, (Hq, Hkv)
        return {
            "x": _w((lambda *s: torch.randn(*s, dtype=torch.bfloat16) * 0.05)(B, Sq, D)),
            "k_cache": _w((lambda *s: torch.randn(*s, dtype=torch.bfloat16) * 1.6)(B, Hkv, Sk, Dh)),
            "v_cache": _w((lambda *s: torch.randn(*s, dtype=torch.bfloat16) * 1.6)(B, Hkv, Sk, Dh)),
            "wq": _w((lambda *s: torch.randn(*s, dtype=torch.bfloat16) * 1.6)(D, Hq * Dh) * (D ** -0.5)),
            "wo": _w((lambda *s: torch.randn(*s, dtype=torch.bfloat16) * 1.6)(Hq * Dh, D) * ((Hq * Dh) ** -0.5)),
        }
    _A_in = _A_setup()

    def _B_setup():
        B, S, D, F = 8, 1, 1024, 3584
        return {
            "x": _w((lambda *s: torch.randn(*s, dtype=torch.bfloat16) * 0.05)(B, S, D)),
            "w1": _w((lambda *s: torch.randn(*s, dtype=torch.bfloat16) * 3.2)(D, F) * (D ** -0.5)),
            "b1": _w((lambda *s: torch.randn(*s, dtype=torch.bfloat16) * 0.8)(F)),
            "w2": _w((lambda *s: torch.randn(*s, dtype=torch.bfloat16) * 0.4)(F, D) * (F ** -0.5)),
            "b2": _w((lambda *s: torch.randn(*s, dtype=torch.bfloat16) * 0.4)(D)),
        }
    _B_in = _B_setup()

    return {
        "A_x": _A_in["x"],
        "A_k_cache": _A_in["k_cache"],
        "A_v_cache": _A_in["v_cache"],
        "A_wq": _A_in["wq"],
        "A_wo": _A_in["wo"],
        "B_x": _B_in["x"],
        "B_w1": _B_in["w1"],
        "B_b1": _B_in["b1"],
        "B_w2": _B_in["w2"],
        "B_b2": _B_in["b2"],
    }

def reference(A_x, A_k_cache, A_v_cache, A_wq, A_wo, B_x, B_w1, B_b1, B_w2, B_b2):
    def _A_ref(x, k_cache, v_cache, wq, wo):
        B, Sq, D = x.shape
        Hq, Dh = 32, 128
        Hkv, Sk = k_cache.shape[1], k_cache.shape[2]
        W = min(4096, max(256, Sk // 4))
        rep = Hq // Hkv
        q = (lambda x, *d: x.permute(*d))((x @ wq).reshape(B, Sq, Hq, Dh), 0, 2, 1, 3)
        k = (lambda x, n, axis: torch.repeat_interleave(x, n, dim=axis))(k_cache[:, :, Sk - W:, :], rep, axis=1)
        v = (lambda x, n, axis: torch.repeat_interleave(x, n, dim=axis))(v_cache[:, :, Sk - W:, :], rep, axis=1)
        scores = torch.einsum("bhqd,bhkd->bhqk", q, k) * (Dh ** -0.5)
        p = _softmax(scores, axis=-1)
        o = torch.einsum("bhqk,bhkd->bhqd", p, v)
        return (lambda x, *d: x.permute(*d))(o, 0, 2, 1, 3).reshape(B, Sq, Hq * Dh) @ wo

    def _B_ref(x, w1, b1, w2, b2):
        y = _layernorm(x, axis=-1)
        h = _gelu(torch.einsum("bsd,df->bsf", y, w1) + b1)
        return torch.einsum("bsf,fd->bsd", h, w2) + b2

    x = A_x
    x = x + _A_ref(_layernorm(x, axis=-1), A_k_cache, A_v_cache, A_wq, A_wo)
    x = x + _B_ref(_layernorm(x, axis=-1), B_w1, B_b1, B_w2, B_b2)
    x = x + _A_ref(_layernorm(x, axis=-1), A_k_cache, A_v_cache, A_wq, A_wo)
    x = x + _B_ref(_layernorm(x, axis=-1), B_w1, B_b1, B_w2, B_b2)
    return x
```

```asm
; @launch grid=(256,1,1) block=(256,1,1) lds=146432
.amdgcn_target "amdgcn-amd-amdhsa--gfx950"
.text
.globl interleave_layers__sliding_block_cached__mixer_channel_mlp__decode_kernel
.p2align 8
.type interleave_layers__sliding_block_cached__mixer_channel_mlp__decode_kernel,@function
interleave_layers__sliding_block_cached__mixer_channel_mlp__decode_kernel:
    s_cmp_ge_u32 s2, 256
    s_cbranch_scc1 L_end
    s_load_dwordx2 s[48:49], s[0:1], 96
    s_load_dwordx2 s[16:17], s[0:1], 24
    s_load_dwordx2 s[4:5], s[0:1], 0
    s_load_dwordx2 s[8:9], s[0:1], 8
    s_load_dwordx2 s[12:13], s[0:1], 16
    s_load_dwordx2 s[20:21], s[0:1], 32
    s_load_dwordx2 s[24:25], s[0:1], 48
    s_load_dwordx2 s[28:29], s[0:1], 56
    s_load_dwordx2 s[32:33], s[0:1], 64
    s_load_dwordx2 s[36:37], s[0:1], 72
    s_load_dwordx2 s[40:41], s[0:1], 80
    s_load_dwordx2 s[44:45], s[0:1], 96
    s_load_dwordx2 s[52:53], s[0:1], 96
    v_lshrrev_b32 v5, 6, v0
    v_and_b32 v1, 63, v0
    v_readfirstlane_b32 s56, v5
    s_mov_b32 s6, 0x4000
    s_mov_b32 s7, 0x20000
    s_mov_b32 s10, 0x2000000
    s_mov_b32 s11, 0x20000
    s_mov_b32 s14, 0x2000000
    s_mov_b32 s15, 0x20000
    s_mov_b32 s18, 0x800000
    s_mov_b32 s19, 0x20000
    s_mov_b32 s22, 0x800000
    s_mov_b32 s23, 0x20000
    s_mov_b32 s26, 0x700000
    s_mov_b32 s27, 0x20000
    s_mov_b32 s30, 0x1c00
    s_mov_b32 s31, 0x20000
    s_mov_b32 s34, 0x700000
    s_mov_b32 s35, 0x20000
    s_mov_b32 s38, 0x800
    s_mov_b32 s39, 0x20000
    s_mov_b32 s42, 0x4000
    s_mov_b32 s43, 0x20000
    s_mov_b32 s46, 0x228880
    s_mov_b32 s47, 0x20000
    s_mov_b32 s50, 0x6a8880
    s_mov_b32 s51, 0x20000
    s_mov_b32 s54, 0x228880
    s_mov_b32 s55, 0x20000
    s_and_b32 s57, s2, 7
    s_lshr_b32 s58, s2, 3
    s_and_b32 s59, s58, 3
    s_lshr_b32 s60, s58, 2
    s_lshr_b32 s61, s58, 3
    s_and_b32 s62, s58, 7
    s_mul_i32 s63, s2, 8704
    s_lshl_b32 s68, s56, 10
    v_lshlrev_b32 v6, 4, v1
    v_lshrrev_b32 v7, 3, v1
    v_and_b32 v4, 7, v1
    v_and_b32 v8, 2, v7
    s_and_b32 s81, s56, 1
    s_lshl_b32 s82, s81, 2
    v_or_b32 v8, s82, v8
    v_xor_b32 v8, v4, v8
    v_lshlrev_b32 v8, 4, v8
    s_lshl_b32 s82, s56, 3
    v_add_u32 v9, s82, v7
    v_lshl_add_u32 v43, v9, 13, v8
    v_mul_u32_u24 v44, 7168, v9
    v_add_u32 v44, v44, v8
    s_lshl_b32 s82, s60, 2
    s_lshr_b32 s82, 0x37654210, s82
    s_and_b32 s82, s82, 7
    s_lshl_b32 s83, s57, 3
    s_add_u32 s82, s82, s83
    s_lshl_b32 s82, s82, 7
    s_lshl_b32 s69, s59, 21
    s_add_u32 s69, s69, s82
    s_lshl_b32 s82, s57, 2
    s_add_u32 s82, s82, s61
    s_lshl_b32 s82, s82, 20
    s_lshl_b32 s83, s62, 15
    s_add_u32 s73, s82, s83
    s_add_u32 s73, s73, 786432
    v_and_b32 v2, 15, v1
    v_lshrrev_b32 v3, 4, v1
    s_lshl_b32 s81, s56, 2
    v_add_u32 v11, s81, v3
    v_xor_b32 v12, v2, v11
    v_lshlrev_b32 v12, 4, v12
    v_lshl_add_u32 v47, v11, 8, v12
    v_and_b32 v12, 7, v11
    v_lshlrev_b32 v12, 1, v12
    v_xor_b32 v12, v2, v12
    v_lshlrev_b32 v12, 4, v12
    v_lshl_add_u32 v46, v11, 8, v12
    v_lshl_add_u32 v45, v11, 11, v12
    v_mov_b32 v240, 0x228800
    s_waitcnt lgkmcnt(0)
    s_getpc_b64 s[84:85]
L_pc:
    s_sub_u32 s84, s84, L_pc-interleave_layers__sliding_block_cached__mixer_channel_mlp__decode_kernel
    s_subb_u32 s85, s85, 0
    s_lshl_b32 s80, s58, 12
    s_add_u32 s80, s80, s68
    s_cmp_lt_u32 s80, L_end-interleave_layers__sliding_block_cached__mixer_channel_mlp__decode_kernel-1024
    s_cbranch_scc0 L_nopf
    v_add_u32 v10, s80, v6
    global_load_dwordx4 v[236:239], v10, s[84:85]
L_nopf:
    s_add_u32 s80, s68, 0
    s_mov_b32 s81, s69
    s_mov_b32 m0, s80
    s_add_u32 s80, s80, 4096
    buffer_load_dwordx4 v43, s[16:19], s81 offen nt lds
    s_add_u32 s81, s81, 262144
    s_mov_b32 m0, s80
    s_add_u32 s80, s80, 4096
    buffer_load_dwordx4 v43, s[16:19], s81 offen nt lds
    s_add_u32 s81, s81, 262144
    s_mov_b32 m0, s80
    s_add_u32 s80, s80, 4096
    buffer_load_dwordx4 v43, s[16:19], s81 offen nt lds
    s_add_u32 s81, s81, 262144
    s_mov_b32 m0, s80
    s_add_u32 s80, s80, 4096
    buffer_load_dwordx4 v43, s[16:19], s81 offen nt lds
    s_add_u32 s81, s81, 262144
    s_mov_b32 m0, s80
    s_add_u32 s80, s80, 4096
    buffer_load_dwordx4 v43, s[16:19], s81 offen nt lds
    s_add_u32 s81, s81, 262144
    s_mov_b32 m0, s80
    s_add_u32 s80, s80, 4096
    buffer_load_dwordx4 v43, s[16:19], s81 offen nt lds
    s_add_u32 s81, s81, 262144
    s_mov_b32 m0, s80
    s_add_u32 s80, s80, 4096
    buffer_load_dwordx4 v43, s[16:19], s81 offen nt lds
    s_add_u32 s81, s81, 262144
    s_mov_b32 m0, s80
    s_nop 0
    buffer_load_dwordx4 v43, s[16:19], s81 offen nt lds
    v_bfe_u32 v150, v1, 3, 1
    v_bfe_u32 v153, v1, 2, 1
    s_lshl_b32 s81, s56, 1
    v_add_u32 v153, s81, v153
    v_and_b32 v152, 3, v1
    v_and_b32 v151, 1, v3
    v_lshlrev_b32 v154, 4, v152
    v_lshl_add_u32 v154, v151, 3, v154
    s_mul_i32 s70, s59, 1835008
    s_mul_i32 s81, s57, 896
    s_add_u32 s70, s70, s81
    s_lshl_b32 s81, s60, 7
    s_add_u32 s70, s70, s81
    s_lshl_b32 s81, s57, 2
    s_add_u32 s81, s81, s61
    s_lshl_b32 s71, s81, 18
    s_lshl_b32 s82, s62, 8
    s_add_u32 s71, s71, s82
    s_mul_i32 s72, s57, 917504
    s_mul_i32 s83, s61, 229376
    s_add_u32 s72, s72, s83
    s_add_u32 s72, s72, s82
    s_mov_b32 s74, 139264
    s_mov_b32 s77, 557056
    s_mov_b32 s75, 278528
    s_mov_b32 s78, 1114112
    s_mov_b32 s76, 417792
    s_mov_b32 s79, 1671168
    s_mov_b32 s64, 0
    s_mov_b32 s65, 0
    s_mov_b32 s67, 100000
    v_mov_b32 v92, 0xc0135761
    v_mov_b32 v93, 0xc0135761
    v_mov_b32 v94, 1.0
    v_mov_b32 v95, 1.0
    v_mov_b32 v64, 0x3f803f80
    v_mov_b32 v65, 0x3f803f80
    v_mov_b32 v66, 0x3f803f80
    v_mov_b32 v67, 0x3f803f80
    s_getreg_b32 s94, hwreg(HW_REG_XCC_ID, 0, 4)
    v_lshrrev_b32 v8, 1, v3
    s_lshl_b32 s80, s56, 5
    v_lshlrev_b32 v24, 7, v4
    v_lshl_add_u32 v24, v3, 3, v24
    v_add_u32 v24, s80, v24
    v_xor_b32 v5, v4, v3
    v_lshlrev_b32 v5, 4, v5
    v_lshl_add_u32 v32, v3, 7, v5
    v_add_u32 v32, 131072, v32
    v_xor_b32 v33, 64, v32
    v_lshlrev_b32 v5, 4, v4
    v_lshl_add_u32 v34, v3, 7, v5
    v_lshl_add_u32 v34, v150, 9, v34
    v_add_u32 v34, 131072, v34
    v_add_u32 v30, s68, v34
    v_lshlrev_b32 v35, 4, v4
    v_add_u32 v35, 135168, v35
    v_lshl_add_u32 v31, v151, 7, v35
    s_lshl_b32 s80, s56, 2
    v_add_u32 v31, s80, v31
    v_bfe_u32 v5, v1, 2, 2
    v_lshrrev_b32 v6, 1, v5
    v_lshl_add_u32 v6, v151, 1, v6
    v_xor_b32 v6, s56, v6
    v_lshlrev_b32 v6, 5, v6
    v_lshl_add_u32 v6, v152, 3, v6
    v_lshl_add_u32 v9, v3, 3, v5
    v_lshl_add_u32 v41, v9, 7, v6
    s_lshl_b32 s80, s57, 11
    s_lshl_b32 s81, s58, 6
    s_add_u32 s81, s81, s80
    s_add_u32 s81, s81, 2244608
    v_lshlrev_b32 v29, 3, v153
    v_lshl_add_u32 v29, v151, 2, v29
    v_add_u32 v29, s81, v29
    v_lshlrev_b32 v10, 11, v4
    v_lshl_add_u32 v10, v150, 6, v10
    v_lshl_add_u32 v10, v3, 4, v10
    s_lshl_b32 s80, s56, 9
    buffer_load_dwordx4 v[220:223], v10, s[4:7], s80 offen offset:0
    buffer_load_dwordx4 v[224:227], v10, s[4:7], s80 offen offset:128
    buffer_load_dwordx4 v[228:231], v10, s[4:7], s80 offen offset:256
    buffer_load_dwordx4 v[232:235], v10, s[4:7], s80 offen offset:384
    v_lshl_add_u32 v28, v153, 11, v154
    s_lshl_b32 s81, s58, 6
    buffer_load_dwordx2 v[80:81], v28, s[4:7], s81 offen
    buffer_load_dwordx2 v[88:89], v154, s[36:39], s81 offen
    v_lshlrev_b32 v16, 4, v2
    v_lshl_add_u32 v16, v151, 3, v16
    s_mul_i32 s81, s57, 896
    s_mul_i32 s82, s61, 224
    s_add_u32 s81, s81, s82
    buffer_load_dwordx2 v[84:85], v16, s[28:31], s81 offen
    buffer_load_dwordx2 v[242:243], v240, s[48:51], 0 offen sc1
    s_add_u32 s44, s44, 0x240000
    s_addc_u32 s45, s45, 0
    s_mov_b64 s[84:85], 0
    s_mov_b32 s36, 0xbdd2d3e8
    s_mov_b32 s37, 0xbdd2d3e8
    s_mov_b32 s28, 0x3e0293ee
    s_mov_b32 s30, 0x3a800000
    s_mov_b32 s29, 0x3e0293ee
    s_mov_b32 s31, 0x3a800000
    s_mov_b32 s38, 0x3727c5ac
    s_mov_b32 s4, 0x00ff00ff
    s_mov_b32 s5, 0x00ff00ff
    s_mov_b32 s6, 0xff
    s_mov_b32 s7, 0xff
    s_lshl_b32 s82, s61, 12
    s_lshl_b32 s83, s57, 6
    s_add_u32 s82, s82, s83
    s_lshl_b32 s83, s62, 3
    s_add_u32 s82, s82, s83
    s_add_u32 s82, s82, 2228224
    v_lshlrev_b32 v26, 9, v4
    v_add_u32 v26, s82, v26
    v_mov_b32 v96, -1
    v_mov_b32 v97, -1
    v_mov_b32 v98, -1
    v_mov_b32 v99, -1
    v_lshlrev_b32 v6, 4, v1
    s_lshl_b32 s80, s56, 11
    s_add_u32 s80, s80, s63
    buffer_store_dwordx4 v[96:99], v6, s[48:51], s80 offen offset:1024 sc1
    s_cmp_eq_u32 s56, 3
    s_cselect_b32 exec_hi, 0, -1
    buffer_store_dwordx4 v[96:99], v6, s[48:51], s80 offen offset:2048 sc1
    s_cmp_eq_u32 s56, 1
    s_cbranch_scc0 L_clr1
    s_mov_b64 exec, 0xf
    s_lshl_b32 s80, s57, 11
    s_lshl_b32 s81, s58, 6
    s_add_u32 s80, s80, s81
    s_add_u32 s80, s80, 2244608
    buffer_store_dwordx4 v[96:99], v6, s[48:51], s80 offen sc1
L_clr1:
    s_cmp_eq_u32 s56, 2
    s_cbranch_scc0 L_clr2
    s_mov_b64 exec, 0xff
    buffer_store_dwordx2 v[96:97], v26, s[48:51], 0 offen sc1
L_clr2:
    s_mov_b64 exec, -1
    s_add_u32 s80, s68, 32768
    s_mov_b32 s81, s73
    s_mov_b32 m0, s80
    s_add_u32 s80, s80, 4096
    buffer_load_dwordx4 v47, s[8:11], s81 offen nt lds
    s_add_u32 s81, s81, 4096
    s_mov_b32 m0, s80
    s_add_u32 s80, s80, 4096
    buffer_load_dwordx4 v47, s[8:11], s81 offen nt lds
    s_add_u32 s81, s81, 4096
    s_mov_b32 m0, s80
    s_add_u32 s80, s80, 4096
    buffer_load_dwordx4 v47, s[8:11], s81 offen nt lds
    s_add_u32 s81, s81, 4096
    s_mov_b32 m0, s80
    s_add_u32 s80, s80, 4096
    buffer_load_dwordx4 v47, s[8:11], s81 offen nt lds
    s_add_u32 s81, s81, 4096
    s_mov_b32 m0, s80
    s_add_u32 s80, s80, 4096
    buffer_load_dwordx4 v47, s[8:11], s81 offen nt lds
    s_add_u32 s81, s81, 4096
    s_mov_b32 m0, s80
    s_add_u32 s80, s80, 4096
    buffer_load_dwordx4 v47, s[8:11], s81 offen nt lds
    s_add_u32 s81, s81, 4096
    s_mov_b32 m0, s80
    s_add_u32 s80, s80, 4096
    buffer_load_dwordx4 v47, s[8:11], s81 offen nt lds
    s_add_u32 s81, s81, 4096
    s_mov_b32 m0, s80
    s_nop 0
    buffer_load_dwordx4 v47, s[8:11], s81 offen nt lds
    s_waitcnt vmcnt(8)
    v_readfirstlane_b32 s92, v242
    v_readfirstlane_b32 s93, v243
    s_add_u32 s92, s92, 1
    s_mul_i32 s95, s92, 0x9e3779b1
    s_mul_i32 s80, s93, 0x85ebca6b
    s_xor_b32 s95, s95, s80
    s_or_b32 s95, s95, 1
    v_mov_b32 v112, 0
    v_mov_b32 v113, 0
    v_dot2_f32_bf16 v112, v220, v64, v112
    v_dot2_f32_bf16 v112, v221, v64, v112
    v_dot2_f32_bf16 v112, v222, v64, v112
    v_dot2_f32_bf16 v112, v223, v64, v112
    v_dot2_f32_bf16 v112, v224, v64, v112
    v_dot2_f32_bf16 v112, v225, v64, v112
    v_dot2_f32_bf16 v112, v226, v64, v112
    v_dot2_f32_bf16 v112, v227, v64, v112
    v_dot2_f32_bf16 v112, v228, v64, v112
    v_dot2_f32_bf16 v112, v229, v64, v112
    v_dot2_f32_bf16 v112, v230, v64, v112
    v_dot2_f32_bf16 v112, v231, v64, v112
    v_dot2_f32_bf16 v112, v232, v64, v112
    v_dot2_f32_bf16 v112, v233, v64, v112
    v_dot2_f32_bf16 v112, v234, v64, v112
    v_dot2_f32_bf16 v112, v235, v64, v112
    v_dot2_f32_bf16 v113, v220, v220, v113
    v_dot2_f32_bf16 v113, v221, v221, v113
    v_dot2_f32_bf16 v113, v222, v222, v113
    v_dot2_f32_bf16 v113, v223, v223, v113
    v_dot2_f32_bf16 v113, v224, v224, v113
    v_dot2_f32_bf16 v113, v225, v225, v113
    v_dot2_f32_bf16 v113, v226, v226, v113
    v_dot2_f32_bf16 v113, v227, v227, v113
    v_dot2_f32_bf16 v113, v228, v228, v113
    v_dot2_f32_bf16 v113, v229, v229, v113
    v_dot2_f32_bf16 v113, v230, v230, v113
    v_dot2_f32_bf16 v113, v231, v231, v113
    v_dot2_f32_bf16 v113, v232, v232, v113
    v_dot2_f32_bf16 v113, v233, v233, v113
    v_dot2_f32_bf16 v113, v234, v234, v113
    v_dot2_f32_bf16 v113, v235, v235, v113
    s_cmp_eq_u32 s56, s59
    s_cbranch_scc0 L_nofr
    ds_write_b128 v34, v[220:223] offset:0
    ds_write_b128 v34, v[224:227] offset:1024
    ds_write_b128 v34, v[228:231] offset:2048
    ds_write_b128 v34, v[232:235] offset:3072
L_nofr:
    s_nop 1
    v_permlane16_swap_b32 v112, v113
    v_add_f32 v112, v112, v113
    s_nop 1
    v_add_f32_dpp v112, v112, v112 row_ror:8 row_mask:0xf bank_mask:0xf
    v_mov_b32 v113, v112
    s_nop 1
    v_permlane32_swap_b32 v112, v113
    v_add_f32 v112, v112, v113
    ds_write_b32 v31, v112
    v_and_b32 v83, 0xffff0000, v81
    v_lshlrev_b32 v82, 16, v81
    v_and_b32 v81, 0xffff0000, v80
    v_lshlrev_b32 v80, 16, v80
    v_and_b32 v87, 0xffff0000, v85
    v_lshlrev_b32 v86, 16, v85
    v_and_b32 v85, 0xffff0000, v84
    v_lshlrev_b32 v84, 16, v84
    v_and_b32 v91, 0xffff0000, v89
    v_lshlrev_b32 v90, 16, v89
    v_and_b32 v89, 0xffff0000, v88
    v_lshlrev_b32 v88, 16, v88
    v_mul_f32 v76, 0.5, v80
    v_mul_f32 v88, 0.5, v88
    v_mul_f32 v77, 0.5, v81
    v_mul_f32 v89, 0.5, v89
    v_mul_f32 v78, 0.5, v82
    v_mul_f32 v90, 0.5, v90
    v_mul_f32 v79, 0.5, v83
    v_mul_f32 v91, 0.5, v91
    s_waitcnt lgkmcnt(0)
    s_barrier
    s_cmp_eq_u32 s56, 0
    s_cbranch_scc0 L_noflag
    s_not_b32 s80, s95
    s_xor_b32 s80, s80, s94
    v_mov_b32 v240, s95
    v_mov_b32 v241, s80
    s_lshl_b32 s81, s2, 3
    v_mov_b32 v242, 0x228000
    s_mov_b64 exec, 0x1
    buffer_store_dwordx2 v[240:241], v242, s[48:51], s81 offen sc1
    s_mov_b64 exec, -1
L_noflag:
    ds_read_b64_tr_b16 a[0:1], v41 offset:0
    ds_read_b64_tr_b16 a[2:3], v41 offset:512
    ds_read_b64_tr_b16 a[4:5], v41 offset:4096
    ds_read_b64_tr_b16 a[6:7], v41 offset:4608
    ds_read_b64_tr_b16 a[8:9], v41 offset:8192
    ds_read_b64_tr_b16 a[10:11], v41 offset:8704
    ds_read_b64_tr_b16 a[12:13], v41 offset:12288
    ds_read_b64_tr_b16 a[14:15], v41 offset:12800
    ds_read_b64_tr_b16 a[16:17], v41 offset:16384
    ds_read_b64_tr_b16 a[18:19], v41 offset:16896
    ds_read_b64_tr_b16 a[20:21], v41 offset:20480
    ds_read_b64_tr_b16 a[22:23], v41 offset:20992
    ds_read_b64_tr_b16 a[24:25], v41 offset:24576
    ds_read_b64_tr_b16 a[26:27], v41 offset:25088
    ds_read_b64_tr_b16 a[28:29], v41 offset:28672
    ds_read_b64_tr_b16 a[30:31], v41 offset:29184
    s_waitcnt lgkmcnt(0)
    v_mfma_f32_16x16x32_bf16 v[68:71], a[0:3], v[64:67], 0
    v_mfma_f32_16x16x32_bf16 v[68:71], a[4:7], v[64:67], v[68:71]
    v_mfma_f32_16x16x32_bf16 v[68:71], a[8:11], v[64:67], v[68:71]
    v_mfma_f32_16x16x32_bf16 v[68:71], a[12:15], v[64:67], v[68:71]
    v_mfma_f32_16x16x32_bf16 v[68:71], a[16:19], v[64:67], v[68:71]
    v_mfma_f32_16x16x32_bf16 v[68:71], a[20:23], v[64:67], v[68:71]
    v_mfma_f32_16x16x32_bf16 v[68:71], a[24:27], v[64:67], v[68:71]
    v_mfma_f32_16x16x32_bf16 v[68:71], a[28:31], v[64:67], v[68:71]
    s_branch L_Q_post
L_layer:
    s_sleep 5
    buffer_load_dwordx2 v[112:113], v18, s[48:51], 0 offen offset:0 sc1
    buffer_load_dwordx4 v[96:99], v17, s[48:51], 0 offen offset:0 sc1
    s_waitcnt vmcnt(0)
L_Q_b:
    ds_write_b128 v30, v[96:99] offset:0
    v_bitop3_b32 v16, v112, v113, v96 bitop3:0x80
    v_permlane16_swap_b32 v112, v113
    v_add_f32 v112, v112, v113
    v_bitop3_b32 v16, v16, v97, v98 bitop3:0x80
    v_bitop3_b32 v16, v16, v99, v99 bitop3:0x80
    v_add_f32_dpp v112, v112, v112 row_ror:8 row_mask:0xf bank_mask:0xf
    v_mov_b32 v113, v112
    v_and_b32 v16, 1, v16
    v_cmp_ne_u32 vcc, 1, v16
    v_permlane32_swap_b32 v112, v113
    v_add_f32 v112, v112, v113
    ds_write_b32 v31, v112
    s_cbranch_vccnz L_Q_r
L_Q_c:
    v_mfma_f32_32x32x16_bf16 v[156:171], v[64:67], v[64:67], 0
    s_waitcnt lgkmcnt(0)
    s_barrier
L_Q_post:
    ds_read_b128 v[176:179], v34 offset:0
    ds_read_b128 v[236:239], v35
    ds_read_b128 v[240:243], v35 offset:128
    ds_read_b128 v[180:183], v34 offset:1024
    ds_read_b128 v[184:187], v34 offset:2048
    ds_read_b128 v[188:191], v34 offset:3072
    v_mfma_f32_16x16x32_bf16 v[172:175], v[64:67], v[64:67], 0
    s_waitcnt lgkmcnt(5)
    v_mfma_f32_16x16x32_bf16 v[208:211], a[0:3], v[176:179], 0
    v_mfma_f32_16x16x32_bf16 v[212:215], a[4:7], v[176:179], 0
    s_waitcnt lgkmcnt(2)
    v_pk_add_f32 v[236:237], v[236:237], v[238:239]
    v_pk_add_f32 v[240:241], v[240:241], v[242:243]
    v_mfma_f32_16x16x32_bf16 v[208:211], a[8:11], v[180:183], v[208:211]
    v_add_f32 v236, v236, v237
    v_add_f32 v237, v240, v241
    v_mfma_f32_16x16x32_bf16 v[212:215], a[12:15], v[180:183], v[212:215]
    s_waitcnt lgkmcnt(1)
    v_pk_mul_f32 v[236:237], v[236:237], s[30:31]
    v_fma_f32 v237, -v236, v236, v237
    v_mfma_f32_16x16x32_bf16 v[208:211], a[16:19], v[184:187], v[208:211]
    v_max_f32 v237, 0, v237
    v_add_f32 v238, s38, v237
    v_mfma_f32_16x16x32_bf16 v[212:215], a[20:23], v[184:187], v[212:215]
    s_waitcnt lgkmcnt(0)
    v_rsq_f32 v114, v238
    v_mfma_f32_16x16x32_bf16 v[208:211], a[24:27], v[188:191], v[208:211]
    v_mul_f32 v115, -v236, v114
    v_mfma_f32_16x16x32_bf16 v[212:215], a[28:31], v[188:191], v[212:215]
    v_pk_mul_f32 v[240:241], v[68:69], v[114:115] op_sel:[0,1] op_sel_hi:[1,1]
    v_pk_mul_f32 v[242:243], v[70:71], v[114:115] op_sel:[0,1] op_sel_hi:[1,1]
    s_nop 5
    v_add_f32_dpp v208, v212, v208 row_ror:8 row_mask:0xf bank_mask:0xf
    v_add_f32_dpp v209, v213, v209 row_ror:8 row_mask:0xf bank_mask:0xf
    v_add_f32_dpp v210, v214, v210 row_ror:8 row_mask:0xf bank_mask:0xf
    v_add_f32_dpp v211, v215, v211 row_ror:8 row_mask:0xf bank_mask:0xf
    s_mov_b64 exec, s[4:5]
    v_pk_fma_f32 v[208:209], v[208:209], v[114:115], v[240:241] op_sel_hi:[1,0,1]
    v_pk_fma_f32 v[210:211], v[210:211], v[114:115], v[242:243] op_sel_hi:[1,0,1]
    v_cvt_pk_bf16_f32 v216, v208, v209
    v_cvt_pk_bf16_f32 v217, v210, v211
    v_and_b32 v216, -2, v216
    v_and_b32 v217, -2, v217
    buffer_store_dwordx2 v[216:217], v24, s[52:55], s63 offen offset:0 sc1
    s_mov_b64 exec, -1
    s_cmp_eq_u32 s64, 0
    s_cbranch_scc1 L_A_l0
    s_sleep 12
    buffer_load_dwordx4 v[96:99], v19, s[52:55], 0 offen offset:0 sc1
    buffer_load_dwordx4 v[100:103], v19, s[52:55], s74 offen offset:0 sc1
    s_waitcnt vmcnt(0)
L_A_b:
    v_mfma_f32_16x16x32_bf16 v[208:211], v[56:59], v[96:99], 0
    v_mfma_f32_16x16x32_bf16 v[208:211], v[56:59], v[100:103], v[208:211]
    v_bitop3_b32 v16, v96, v97, v98 bitop3:0xfe
    v_bitop3_b32 v16, v16, v99, v100 bitop3:0xfe
    v_bitop3_b32 v16, v16, v101, v102 bitop3:0xfe
    v_bitop3_b32 v16, v16, v103, v103 bitop3:0xfe
    s_nop 3
    v_cvt_pk_bf16_f32 v216, v208, v209
    v_cvt_pk_bf16_f32 v217, v210, v211
    ds_write_b64 v36, v[216:217] offset:6144
    v_and_b32 v16, 1, v16
    v_cmp_ne_u32 vcc, 0, v16
    s_cbranch_vccnz L_A_r
L_A_c:
    v_mfma_f32_32x32x16_bf16 v[156:171], v[64:67], v[64:67], 0
    s_waitcnt lgkmcnt(0)
    s_barrier
    ds_read_b128 v[176:179], v32 offset:6144
    ds_read_b128 v[180:183], v33 offset:6656
    ds_read_b128 v[184:187], v32 offset:7168
    ds_read_b128 v[188:191], v33 offset:7680
    v_mfma_f32_16x16x32_bf16 v[172:175], v[64:67], v[64:67], 0
    s_waitcnt lgkmcnt(3)
    v_mfma_f32_16x16x32_bf16 v[208:211], a[32:35], v[176:179], 0
    v_mfma_f32_16x16x32_bf16 v[212:215], a[48:51], v[176:179], 0
    s_waitcnt lgkmcnt(2)
    v_mfma_f32_16x16x32_bf16 v[208:211], a[36:39], v[180:183], v[208:211]
    v_mfma_f32_16x16x32_bf16 v[212:215], a[52:55], v[180:183], v[212:215]
    s_waitcnt lgkmcnt(1)
    v_mfma_f32_16x16x32_bf16 v[208:211], a[40:43], v[184:187], v[208:211]
    v_mfma_f32_16x16x32_bf16 v[212:215], a[56:59], v[184:187], v[212:215]
    s_waitcnt lgkmcnt(0)
    v_mfma_f32_16x16x32_bf16 v[208:211], a[44:47], v[188:191], v[208:211]
    v_mfma_f32_16x16x32_bf16 v[212:215], a[60:63], v[188:191], v[212:215]
    s_nop 6
    v_max3_f32 v236, v208, v209, v210
    v_max3_f32 v237, v212, v213, v214
    v_max3_f32 v236, v236, v211, v215
    v_max_f32 v236, v236, v237
    v_mul_f32 v236, s28, v236
    v_ceil_f32 v236, v236
    v_pk_fma_f32 v[208:209], v[208:209], s[28:29], v[236:237] op_sel_hi:[1,1,0] neg_lo:[0,0,1] neg_hi:[0,0,1]
    v_pk_fma_f32 v[210:211], v[210:211], s[28:29], v[236:237] op_sel_hi:[1,1,0] neg_lo:[0,0,1] neg_hi:[0,0,1]
    v_pk_fma_f32 v[212:213], v[212:213], s[28:29], v[236:237] op_sel_hi:[1,1,0] neg_lo:[0,0,1] neg_hi:[0,0,1]
    v_pk_fma_f32 v[214:215], v[214:215], s[28:29], v[236:237] op_sel_hi:[1,1,0] neg_lo:[0,0,1] neg_hi:[0,0,1]
    v_exp_f32 v208, v208
    v_exp_f32 v209, v209
    v_exp_f32 v210, v210
    v_exp_f32 v211, v211
    v_exp_f32 v212, v212
    v_exp_f32 v213, v213
    v_exp_f32 v214, v214
    v_exp_f32 v215, v215
    v_cvt_i32_f32 v238, v236
    v_lshlrev_b32 v238, 7, v238
    v_cvt_pk_bf16_f32 v216, v208, v209
    v_cvt_pk_bf16_f32 v217, v210, v211
    v_cvt_pk_bf16_f32 v218, v212, v213
    v_cvt_pk_bf16_f32 v219, v214, v215
    ds_write_b128 v38, v[216:219] offset:8192
    v_dot2_f32_bf16 v239, v216, v64, 0
    v_dot2_f32_bf16 v239, v217, v64, v239
    v_dot2_f32_bf16 v239, v218, v64, v239
    v_dot2_f32_bf16 v239, v219, v64, v239
    s_nop 2
    ds_write2st64_b32 v39, v238, v239 offset0:0 offset1:2
    v_mfma_f32_32x32x16_bf16 v[156:171], v[64:67], v[64:67], 0
    s_waitcnt lgkmcnt(0)
    s_barrier
    ds_read_b128 v[236:239], v40
    ds_read_b128 v[176:179], v32 offset:8192
    ds_read_b128 v[180:183], v33 offset:8704
    ds_read_b128 v[184:187], v32 offset:9216
    ds_read_b128 v[188:191], v33 offset:9728
    ds_read_b128 v[240:243], v40 offset:512
    s_mov_b32 s80, 0x7f80
    v_mfma_f32_16x16x32_bf16 v[172:175], v[64:67], v[64:67], 0
    s_waitcnt lgkmcnt(5)
    v_max3_i32 v5, v236, v237, v238
    v_max_i32 v10, v5, v239
    v_max_i32 v5, v5, v239
    s_nop 1
    v_permlane16_swap_b32 v5, v10
    v_max_i32 v11, v5, v10
    v_max_i32 v5, v5, v10
    s_nop 1
    v_permlane32_swap_b32 v5, v11
    v_max_i32 v5, v5, v11
    v_sub_u32 v236, v5, v236
    v_sub_u32 v237, v5, v237
    v_sub_u32 v238, v5, v238
    v_sub_u32 v239, v5, v239
    v_min_u32 v6, s80, v236
    v_min_u32 v7, s80, v237
    v_min_u32 v8, s80, v238
    v_min_u32 v9, s80, v239
    s_waitcnt lgkmcnt(0)
    v_pk_sub_u16 v176, v176, v6 op_sel_hi:[1,0] clamp
    v_pk_sub_u16 v177, v177, v6 op_sel_hi:[1,0] clamp
    v_pk_sub_u16 v178, v178, v6 op_sel_hi:[1,0] clamp
    v_pk_sub_u16 v179, v179, v6 op_sel_hi:[1,0] clamp
    v_lshlrev_b32 v236, 16, v6
    v_lshlrev_b32 v237, 16, v7
    v_mfma_f32_16x16x32_bf16 v[208:211], a[64:67], v[176:179], 0
    v_pk_sub_u16 v180, v180, v7 op_sel_hi:[1,0] clamp
    v_pk_sub_u16 v181, v181, v7 op_sel_hi:[1,0] clamp
    v_pk_sub_u16 v182, v182, v7 op_sel_hi:[1,0] clamp
    v_pk_sub_u16 v183, v183, v7 op_sel_hi:[1,0] clamp
    v_mfma_f32_16x16x32_bf16 v[212:215], a[80:83], v[176:179], 0
    s_nop 0
    v_mfma_f32_16x16x32_bf16 v[208:211], a[68:71], v[180:183], v[208:211]
    v_pk_sub_u16 v184, v184, v8 op_sel_hi:[1,0] clamp
    v_pk_sub_u16 v185, v185, v8 op_sel_hi:[1,0] clamp
    v_pk_sub_u16 v186, v186, v8 op_sel_hi:[1,0] clamp
    v_pk_sub_u16 v187, v187, v8 op_sel_hi:[1,0] clamp
    v_mfma_f32_16x16x32_bf16 v[212:215], a[84:87], v[180:183], v[212:215]
    s_nop 0
    v_mfma_f32_16x16x32_bf16 v[208:211], a[72:75], v[184:187], v[208:211]
    v_pk_sub_u16 v188, v188, v9 op_sel_hi:[1,0] clamp
    v_pk_sub_u16 v189, v189, v9 op_sel_hi:[1,0] clamp
    v_pk_sub_u16 v190, v190, v9 op_sel_hi:[1,0] clamp
    v_pk_sub_u16 v191, v191, v9 op_sel_hi:[1,0] clamp
    v_mfma_f32_16x16x32_bf16 v[212:215], a[88:91], v[184:187], v[212:215]
    s_nop 0
    v_mfma_f32_16x16x32_bf16 v[208:211], a[76:79], v[188:191], v[208:211]
    v_mfma_f32_16x16x32_bf16 v[212:215], a[92:95], v[188:191], v[212:215]
    v_lshlrev_b32 v238, 16, v8
    v_lshlrev_b32 v239, 16, v9
    v_sub_u32_e64 v236, 1.0, v236 clamp
    v_sub_u32_e64 v237, 1.0, v237 clamp
    v_sub_u32_e64 v238, 1.0, v238 clamp
    v_sub_u32_e64 v239, 1.0, v239 clamp
    v_pk_mul_f32 v[240:241], v[240:241], v[236:237]
    s_mov_b64 exec, s[4:5]
    v_cvt_pk_bf16_f32 v216, v208, v209
    v_cvt_pk_bf16_f32 v217, v210, v211
    v_cvt_pk_bf16_f32 v218, v212, v213
    v_cvt_pk_bf16_f32 v219, v214, v215
    v_and_b32 v216, -2, v216
    v_and_b32 v217, -2, v217
    v_and_b32 v218, -2, v218
    v_and_b32 v219, -2, v219
    buffer_store_dwordx4 v[216:219], v25, s[52:55], s63 offen offset:0 sc1
    s_mov_b64 exec, -1
    s_cmp_eq_u32 s56, 0
    s_cbranch_scc0 L_A_nost
    v_pk_fma_f32 v[240:241], v[242:243], v[238:239], v[240:241]
    v_add_f32 v242, v240, v241
    v_add_f32 v240, v240, v241
    v_ashrrev_i32 v112, 6, v5
    s_nop 0
    v_permlane16_swap_b32 v240, v242
    v_add_f32 v241, v240, v242
    v_add_f32 v240, v240, v242
    s_nop 1
    v_permlane32_swap_b32 v240, v241
    v_add_f32 v113, v240, v241
    v_and_b32 v113, -2, v113
    s_mov_b64 exec, 0xff
    buffer_store_dwordx2 v[112:113], v26, s[52:55], 0 offen offset:0 sc1
    s_mov_b64 exec, -1
L_A_nost:
    s_cmp_eq_u32 s64, 0
    s_cbranch_scc1 L_O_l0
    s_sleep 16
    buffer_load_dwordx2 v[112:113], v21, s[52:55], 0 offen offset:0 sc1
    buffer_load_dwordx4 v[96:99], v20, s[52:55], 0 offen offset:0 sc1
    buffer_load_dwordx4 v[100:103], v20, s[52:55], s74 offen offset:0 sc1
    buffer_load_dwordx4 v[104:107], v20, s[52:55], s75 offen offset:0 sc1
    buffer_load_dwordx4 v[108:111], v20, s[52:55], s76 offen offset:0 sc1
    s_waitcnt vmcnt(0)
L_O_b:
    v_max_i32_dpp v236, v112, v112 quad_perm:[1,0,3,2] row_mask:0xf bank_mask:0xf
    v_bitop3_b32 v16, v96, v97, v98 bitop3:0xfe
    v_bitop3_b32 v16, v16, v99, v100 bitop3:0xfe
    v_max_i32_dpp v236, v236, v236 quad_perm:[2,3,0,1] row_mask:0xf bank_mask:0xf
    v_bitop3_b32 v16, v16, v101, v102 bitop3:0xfe
    v_bitop3_b32 v16, v16, v103, v104 bitop3:0xfe
    v_max_i32_dpp v236, v236, v236 row_half_mirror row_mask:0xf bank_mask:0xf
    v_sub_u32 v236, v112, v236
    v_add_u32 v236, 254, v236
    v_max_i32 v236, 0, v236
    v_mul_u32_u24 v236, 0x400040, v236
    v_bitop3_b32 v16, v16, v105, v106 bitop3:0xfe
    v_bitop3_b32 v16, v16, v107, v108 bitop3:0xfe
    v_and_b32_dpp v220, v236, v52 row_newbcast:0 row_mask:0xf bank_mask:0xf
    v_and_b32_dpp v221, v236, v53 row_newbcast:0 row_mask:0xf bank_mask:0xf
    v_and_b32_dpp v222, v236, v54 row_newbcast:0 row_mask:0xf bank_mask:0xf
    v_and_b32_dpp v223, v236, v55 row_newbcast:0 row_mask:0xf bank_mask:0xf
    v_and_b32_dpp v224, v236, v52 row_newbcast:1 row_mask:0xf bank_mask:0xf
    v_and_b32_dpp v225, v236, v53 row_newbcast:1 row_mask:0xf bank_mask:0xf
    v_and_b32_dpp v226, v236, v54 row_newbcast:1 row_mask:0xf bank_mask:0xf
    v_and_b32_dpp v227, v236, v55 row_newbcast:1 row_mask:0xf bank_mask:0xf
    v_mfma_f32_16x16x32_bf16 v[208:211], v[220:223], v[96:99], 0
    v_and_b32_dpp v228, v236, v52 row_newbcast:2 row_mask:0xf bank_mask:0xf
    v_and_b32_dpp v229, v236, v53 row_newbcast:2 row_mask:0xf bank_mask:0xf
    v_and_b32_dpp v230, v236, v54 row_newbcast:2 row_mask:0xf bank_mask:0xf
    v_and_b32_dpp v231, v236, v55 row_newbcast:2 row_mask:0xf bank_mask:0xf
    v_mfma_f32_16x16x32_bf16 v[208:211], v[224:227], v[100:103], v[208:211]
    v_and_b32_dpp v232, v236, v52 row_newbcast:3 row_mask:0xf bank_mask:0xf
    v_and_b32_dpp v233, v236, v53 row_newbcast:3 row_mask:0xf bank_mask:0xf
    v_and_b32_dpp v234, v236, v54 row_newbcast:3 row_mask:0xf bank_mask:0xf
    v_and_b32_dpp v235, v236, v55 row_newbcast:3 row_mask:0xf bank_mask:0xf
    v_mfma_f32_16x16x32_bf16 v[208:211], v[228:231], v[104:107], v[208:211]
    v_and_b32 v237, 0xffff0000, v236
    v_bitop3_b32 v16, v16, v109, v110 bitop3:0xfe
    v_mfma_f32_16x16x32_bf16 v[208:211], v[232:235], v[108:111], v[208:211]
    v_bitop3_b32 v16, v16, v111, v112 bitop3:0xfe
    v_mul_f32 v237, v237, v113
    v_bitop3_b32 v16, v16, v113, v113 bitop3:0xfe
    s_nop 0
    v_add_f32_dpp v237, v237, v237 quad_perm:[1,0,3,2] row_mask:0xf bank_mask:0xf
    s_nop 1
    v_add_f32_dpp v237, v237, v237 quad_perm:[2,3,0,1] row_mask:0xf bank_mask:0xf
    s_nop 1
    v_add_f32_dpp v237, v237, v237 row_half_mirror row_mask:0xf bank_mask:0xf
    v_rcp_f32 v114, v237
    s_nop 0
    v_pk_mul_f32 v[208:209], v[208:209], v[114:115] op_sel_hi:[1,0]
    v_pk_mul_f32 v[210:211], v[210:211], v[114:115] op_sel_hi:[1,0]
    v_cvt_pk_bf16_f32 v216, v208, v209
    v_cvt_pk_bf16_f32 v217, v210, v211
    ds_write_b64 v37, v[216:217] offset:11264
    v_and_b32 v16, 1, v16
    v_cmp_ne_u32 vcc, 0, v16
    s_cbranch_vccnz L_O_r
L_O_c:
    v_mfma_f32_32x32x16_bf16 v[156:171], v[64:67], v[64:67], 0
    s_waitcnt lgkmcnt(0)
    s_barrier
    ds_read_b128 v[176:179], v32 offset:11264
    ds_read_b128 v[180:183], v33 offset:11776
    ds_read_b128 v[184:187], v32 offset:12288
    ds_read_b128 v[188:191], v33 offset:12800
    v_mfma_f32_16x16x32_bf16 v[172:175], v[64:67], v[64:67], 0
    s_waitcnt lgkmcnt(3)
    v_mfma_f32_16x16x32_bf16 v[208:211], a[96:99], v[176:179], 0
    v_mfma_f32_16x16x32_bf16 v[212:215], a[112:115], v[176:179], 0
    s_waitcnt lgkmcnt(2)
    v_mfma_f32_16x16x32_bf16 v[208:211], a[100:103], v[180:183], v[208:211]
    v_mfma_f32_16x16x32_bf16 v[212:215], a[116:119], v[180:183], v[212:215]
    s_waitcnt lgkmcnt(1)
    v_mfma_f32_16x16x32_bf16 v[208:211], a[104:107], v[184:187], v[208:211]
    v_mfma_f32_16x16x32_bf16 v[212:215], a[120:123], v[184:187], v[212:215]
    s_waitcnt lgkmcnt(0)
    v_mfma_f32_16x16x32_bf16 v[208:211], a[108:111], v[188:191], v[208:211]
    v_mfma_f32_16x16x32_bf16 v[212:215], a[124:127], v[188:191], v[212:215]
    s_mov_b64 exec, s[4:5]
    s_nop 5
    v_cvt_pk_bf16_f32 v216, v208, v209
    v_cvt_pk_bf16_f32 v217, v210, v211
    v_cvt_pk_bf16_f32 v218, v212, v213
    v_cvt_pk_bf16_f32 v219, v214, v215
    v_and_b32 v216, -2, v216
    v_and_b32 v217, -2, v217
    v_and_b32 v218, -2, v218
    v_and_b32 v219, -2, v219
    buffer_store_dwordx4 v[216:219], v27, s[52:55], s63 offen offset:0 sc1
    s_mov_b64 exec, -1
    s_cmp_eq_u32 s64, 0
    s_cbranch_scc1 L_X1_l0
    s_sleep 21
    buffer_load_dwordx4 v[96:99], v22, s[52:55], 0 offen offset:0 sc1
    buffer_load_dwordx4 v[100:103], v22, s[52:55], s77 offen offset:0 sc1
    buffer_load_dwordx4 v[104:107], v22, s[52:55], s78 offen offset:0 sc1
    buffer_load_dwordx4 v[108:111], v22, s[52:55], s79 offen offset:0 sc1
    s_waitcnt vmcnt(0)
L_X1_b:
    v_mfma_f32_16x16x32_bf16 v[208:211], v[60:63], v[96:99], v[76:79]
    v_bitop3_b32 v16, v96, v97, v98 bitop3:0xfe
    v_bitop3_b32 v16, v16, v99, v100 bitop3:0xfe
    v_bitop3_b32 v16, v16, v101, v102 bitop3:0xfe
    v_mfma_f32_16x16x32_bf16 v[208:211], v[60:63], v[100:103], v[208:211]
    v_bitop3_b32 v16, v16, v103, v104 bitop3:0xfe
    v_bitop3_b32 v16, v16, v105, v106 bitop3:0xfe
    v_bitop3_b32 v16, v16, v107, v108 bitop3:0xfe
    v_mfma_f32_16x16x32_bf16 v[208:211], v[60:63], v[104:107], v[208:211]
    v_bitop3_b32 v16, v16, v109, v110 bitop3:0xfe
    v_bitop3_b32 v16, v16, v111, v111 bitop3:0xfe
    v_and_b32 v16, 1, v16
    v_mfma_f32_16x16x32_bf16 v[208:211], v[60:63], v[108:111], v[208:211]
    v_cmp_ne_u32 vcc, 0, v16
    s_cbranch_vccnz L_X1_r
L_X1_c:
    s_nop 5
    v_add_f32_dpp v208, v208, v208 row_ror:8 row_mask:0xf bank_mask:0xf
    v_add_f32_dpp v209, v209, v209 row_ror:8 row_mask:0xf bank_mask:0xf
    v_add_f32_dpp v210, v210, v210 row_ror:8 row_mask:0xf bank_mask:0xf
    v_add_f32_dpp v211, v211, v211 row_ror:8 row_mask:0xf bank_mask:0xf
    v_cvt_pk_bf16_f32 v216, v208, v209
    v_cvt_pk_bf16_f32 v217, v210, v211
    v_and_b32 v218, -2, v216
    v_and_b32 v219, -2, v217
    v_dot2_f32_bf16 v236, v218, v64, 0
    v_dot2_f32_bf16 v237, v218, v218, 0
    v_dot2_f32_bf16 v236, v219, v64, v236
    v_dot2_f32_bf16 v237, v219, v219, v237
    s_mov_b64 exec, 0xff00ff
    s_cmp_eq_u32 s66, 0
    s_cbranch_scc1 L_X1x_slow
    buffer_store_dwordx2 v[218:219], v28, s[48:51], s63 offen offset:0
L_X1x_back:
    s_mov_b64 exec, -1
    v_permlane16_swap_b32 v236, v237
    v_add_f32 v236, v236, v237
    s_cmp_eq_u32 s66, 0
    s_nop 0
    v_add_f32_dpp v236, v236, v236 quad_perm:[1,0,3,2] row_mask:0xf bank_mask:0xf
    s_nop 1
    v_add_f32_dpp v236, v236, v236 quad_perm:[2,3,0,1] row_mask:0xf bank_mask:0xf
    v_and_b32 v236, -2, v236
    s_mov_b64 exec, 0x110011
    s_cbranch_scc1 L_X1s_slow
    buffer_store_dword v236, v29, s[48:51], 0 offen offset:0
L_X1s_back:
    s_mov_b64 exec, -1
    v_and_b32 v83, 0xffff0000, v217
    v_lshlrev_b32 v82, 16, v217
    v_and_b32 v81, 0xffff0000, v216
    v_lshlrev_b32 v80, 16, v216
    v_fma_f32 v76, v80, 0.5, v88
    v_fma_f32 v77, v81, 0.5, v89
    v_fma_f32 v78, v82, 0.5, v90
    v_fma_f32 v79, v83, 0.5, v91
    s_cmp_lt_u32 s58, 28
    s_cbranch_scc0 L_skipM
    s_cmp_eq_u32 s64, 0
    s_cbranch_scc1 L_M_l0
    s_sleep 5
    buffer_load_dwordx2 v[112:113], v18, s[48:51], 0 offen offset:0 sc1
    buffer_load_dwordx4 v[96:99], v17, s[48:51], 0 offen offset:0 sc1
    s_waitcnt vmcnt(0)
L_M_b:
    ds_write_b128 v30, v[96:99] offset:0
    v_bitop3_b32 v16, v112, v113, v96 bitop3:0xfe
    v_permlane16_swap_b32 v112, v113
    v_add_f32 v112, v112, v113
    v_bitop3_b32 v16, v16, v97, v98 bitop3:0xfe
    v_bitop3_b32 v16, v16, v99, v99 bitop3:0xfe
    v_add_f32_dpp v112, v112, v112 row_ror:8 row_mask:0xf bank_mask:0xf
    v_mov_b32 v113, v112
    v_and_b32 v16, 1, v16
    v_cmp_ne_u32 vcc, 0, v16
    v_permlane32_swap_b32 v112, v113
    v_add_f32 v112, v112, v113
    ds_write_b32 v31, v112
    s_cbranch_vccnz L_M_r
L_M_c:
    v_mfma_f32_32x32x16_bf16 v[156:171], v[64:67], v[64:67], 0
    s_waitcnt lgkmcnt(0)
    s_barrier
L_M_post:
    ds_read_b128 v[176:179], v34 offset:0
    ds_read_b128 v[236:239], v35
    ds_read_b128 v[240:243], v35 offset:128
    ds_read_b128 v[180:183], v34 offset:1024
    ds_read_b128 v[184:187], v34 offset:2048
    ds_read_b128 v[188:191], v34 offset:3072
    v_mfma_f32_16x16x32_bf16 v[172:175], v[64:67], v[64:67], 0
    s_waitcnt lgkmcnt(5)
    v_mfma_f32_16x16x32_bf16 v[208:211], a[128:131], v[176:179], 0
    v_mfma_f32_16x16x32_bf16 v[212:215], a[132:135], v[176:179], 0
    s_waitcnt lgkmcnt(2)
    v_pk_add_f32 v[236:237], v[236:237], v[238:239]
    v_pk_add_f32 v[240:241], v[240:241], v[242:243]
    v_mfma_f32_16x16x32_bf16 v[208:211], a[136:139], v[180:183], v[208:211]
    v_add_f32 v236, v236, v237
    v_add_f32 v237, v240, v241
    v_mfma_f32_16x16x32_bf16 v[212:215], a[140:143], v[180:183], v[212:215]
    s_waitcnt lgkmcnt(1)
    v_pk_mul_f32 v[236:237], v[236:237], s[30:31]
    v_fma_f32 v237, -v236, v236, v237
    v_mfma_f32_16x16x32_bf16 v[208:211], a[144:147], v[184:187], v[208:211]
    v_max_f32 v237, 0, v237
    v_add_f32 v238, s38, v237
    v_mfma_f32_16x16x32_bf16 v[212:215], a[148:151], v[184:187], v[212:215]
    s_waitcnt lgkmcnt(0)
    v_rsq_f32 v114, v238
    v_mfma_f32_16x16x32_bf16 v[208:211], a[152:155], v[188:191], v[208:211]
    v_mul_f32 v238, v114, v114
    v_fma_f32 v238, v238, v237, s38
    v_mfma_f32_16x16x32_bf16 v[212:215], a[156:159], v[188:191], v[212:215]
    v_rsq_f32 v238, v238
    s_cmp_eq_u32 s66, 0
    v_mul_f32 v114, v114, v238
    v_mul_f32 v115, -v236, v114
    v_pk_mul_f32 v[240:241], v[72:73], v[114:115] op_sel:[0,1] op_sel_hi:[1,1]
    v_pk_mul_f32 v[242:243], v[74:75], v[114:115] op_sel:[0,1] op_sel_hi:[1,1]
    s_nop 1
    v_add_f32_dpp v208, v212, v208 row_ror:8 row_mask:0xf bank_mask:0xf
    v_add_f32_dpp v209, v213, v209 row_ror:8 row_mask:0xf bank_mask:0xf
    v_add_f32_dpp v210, v214, v210 row_ror:8 row_mask:0xf bank_mask:0xf
    v_add_f32_dpp v211, v215, v211 row_ror:8 row_mask:0xf bank_mask:0xf
    s_mov_b64 exec, s[4:5]
    v_pk_fma_f32 v[208:209], v[208:209], v[114:115], v[240:241] op_sel_hi:[1,0,1]
    v_pk_fma_f32 v[210:211], v[210:211], v[114:115], v[242:243] op_sel_hi:[1,0,1]
    v_cvt_pk_bf16_f32 v216, v208, v209
    v_cvt_pk_bf16_f32 v217, v210, v211
    v_and_or_b32 v216, v216, -2, s65
    v_and_or_b32 v217, v217, -2, s65
    s_cbranch_scc1 L_Mp_slow
    buffer_store_dwordx2 v[216:217], v24, s[48:51], s63 offen offset:1024
L_Mp_back:
    s_mov_b64 exec, -1
L_M2:
    s_cmp_eq_u32 s64, 0
    s_cbranch_scc1 L_H_l0
    s_sleep 6
    buffer_load_dwordx4 v[96:99], v23, s[48:51], 0 offen offset:0 sc1
    buffer_load_dwordx4 v[100:103], v23, s[48:51], s74 offen offset:0 sc1
    s_waitcnt vmcnt(0)
L_H_b:
    v_mfma_f32_16x16x32_bf16 v[208:211], v[56:59], v[96:99], v[84:87]
    v_mfma_f32_16x16x32_bf16 v[208:211], v[56:59], v[100:103], v[208:211]
    v_bitop3_b32 v16, v96, v97, v98 bitop3:0x80
    v_bitop3_b32 v16, v16, v99, v100 bitop3:0x80
    v_bitop3_b32 v16, v16, v101, v102 bitop3:0x80
    v_bitop3_b32 v16, v16, v103, v103 bitop3:0x80
    v_and_b32 v16, 1, v16
    v_cmp_ne_u32 vcc, 1, v16
    s_nop 0
    s_and_b64 vcc, vcc, s[84:85]
    v_pk_mul_f32 v[236:237], v[208:209], v[208:209]
    v_pk_mul_f32 v[238:239], v[210:211], v[210:211]
    v_pk_fma_f32 v[236:237], v[236:237], s[36:37], v[92:93]
    v_pk_fma_f32 v[238:239], v[238:239], s[36:37], v[92:93]
    v_pk_mul_f32 v[236:237], v[236:237], v[208:209]
    v_pk_mul_f32 v[238:239], v[238:239], v[210:211]
    v_exp_f32 v236, v236
    v_exp_f32 v237, v237
    v_exp_f32 v238, v238
    v_exp_f32 v239, v239
    v_pk_add_f32 v[236:237], v[236:237], v[94:95]
    v_pk_add_f32 v[238:239], v[238:239], v[94:95]
    v_rcp_f32 v236, v236
    v_rcp_f32 v237, v237
    v_rcp_f32 v238, v238
    v_rcp_f32 v239, v239
    v_pk_mul_f32 v[236:237], v[236:237], v[208:209]
    v_pk_mul_f32 v[238:239], v[238:239], v[210:211]
    v_cvt_pk_bf16_f32 v216, v236, v237
    v_cvt_pk_bf16_f32 v217, v238, v239
    ds_write_b64 v37, v[216:217] offset:13312
    s_cbranch_vccnz L_H_r
L_H_c:
    v_mfma_f32_32x32x16_bf16 v[156:171], v[64:67], v[64:67], 0
    s_waitcnt lgkmcnt(0)
    s_barrier
    ds_read_b128 v[176:179], v32 offset:13312
    ds_read_b128 v[180:183], v33 offset:13824
    ds_read_b128 v[184:187], v32 offset:14336
    ds_read_b64 v[188:189], v33 offset:14848
    v_mfma_f32_16x16x32_bf16 v[172:175], v[64:67], v[64:67], 0
    s_waitcnt lgkmcnt(3)
    v_mfma_f32_16x16x32_bf16 v[208:211], a[160:163], v[176:179], 0
    v_mfma_f32_16x16x32_bf16 v[212:215], a[176:179], v[176:179], 0
    s_waitcnt lgkmcnt(2)
    v_mfma_f32_16x16x32_bf16 v[208:211], a[164:167], v[180:183], v[208:211]
    v_mfma_f32_16x16x32_bf16 v[212:215], a[180:183], v[180:183], v[212:215]
    s_waitcnt lgkmcnt(1)
    v_mfma_f32_16x16x32_bf16 v[208:211], a[168:171], v[184:187], v[208:211]
    v_mfma_f32_16x16x32_bf16 v[212:215], a[184:187], v[184:187], v[212:215]
    s_waitcnt lgkmcnt(0)
    v_mfma_f32_16x16x16_bf16 v[208:211], a[172:173], v[188:189], v[208:211]
    v_mfma_f32_16x16x16_bf16 v[212:215], a[188:189], v[188:189], v[212:215]
    s_mov_b64 exec, s[4:5]
    s_nop 5
    v_cvt_pk_bf16_f32 v216, v208, v209
    v_cvt_pk_bf16_f32 v217, v210, v211
    v_cvt_pk_bf16_f32 v218, v212, v213
    v_cvt_pk_bf16_f32 v219, v214, v215
    v_and_b32 v216, -2, v216
    v_and_b32 v217, -2, v217
    v_and_b32 v218, -2, v218
    v_and_b32 v219, -2, v219
    buffer_store_dwordx4 v[216:219], v27, s[52:55], s63 offen offset:2048 sc1
    s_mov_b64 exec, -1
    s_cmp_eq_u32 s64, 0
    s_cbranch_scc1 L_X2_l0
    s_lshr_b32 s80, s57, 1
    s_cmp_eq_u32 s80, s56
    s_cbranch_scc0 L_fin
    s_sleep 13
    buffer_load_dwordx4 v[96:99], v22, s[52:55], 0 offen offset:2048 sc1
    buffer_load_dwordx4 v[100:103], v22, s[52:55], s77 offen offset:2048 sc1
    buffer_load_dwordx4 v[104:107], v22, s[52:55], s78 offen offset:2048 sc1
    buffer_load_dwordx4 v[108:111], v22, s[52:55], s79 offen offset:2048 sc1
    s_waitcnt vmcnt(0)
L_X2_b:
    v_mfma_f32_16x16x32_bf16 v[208:211], v[60:63], v[96:99], v[76:79]
    v_bitop3_b32 v16, v96, v97, v98 bitop3:0xfe
    v_bitop3_b32 v16, v16, v99, v100 bitop3:0xfe
    v_bitop3_b32 v16, v16, v101, v102 bitop3:0xfe
    v_mfma_f32_16x16x32_bf16 v[208:211], v[60:63], v[100:103], v[208:211]
    v_bitop3_b32 v16, v16, v103, v104 bitop3:0xfe
    v_bitop3_b32 v16, v16, v105, v106 bitop3:0xfe
    v_bitop3_b32 v16, v16, v107, v108 bitop3:0xfe
    v_mfma_f32_16x16x32_bf16 v[208:211], v[60:63], v[104:107], v[208:211]
    v_bitop3_b32 v16, v16, v109, v110 bitop3:0xfe
    v_bitop3_b32 v16, v16, v111, v111 bitop3:0xfe
    v_and_b32 v16, 1, v16
    v_mfma_f32_16x16x32_bf16 v[208:211], v[60:63], v[108:111], v[208:211]
    v_cmp_ne_u32 vcc, 0, v16
    s_cbranch_vccnz L_X2_r
L_X2_c:
    s_nop 5
    v_add_f32_dpp v208, v208, v208 row_ror:8 row_mask:0xf bank_mask:0xf
    v_add_f32_dpp v209, v209, v209 row_ror:8 row_mask:0xf bank_mask:0xf
    v_add_f32_dpp v210, v210, v210 row_ror:8 row_mask:0xf bank_mask:0xf
    v_add_f32_dpp v211, v211, v211 row_ror:8 row_mask:0xf bank_mask:0xf
    v_cvt_pk_bf16_f32 v216, v208, v209
    v_cvt_pk_bf16_f32 v217, v210, v211
    s_cmp_eq_u32 s64, 0
    s_cbranch_scc0 L_out
    v_or_b32 v218, 1, v216
    v_or_b32 v219, 1, v217
    v_dot2_f32_bf16 v236, v218, v64, 0
    v_dot2_f32_bf16 v237, v218, v218, 0
    v_dot2_f32_bf16 v236, v219, v64, v236
    v_dot2_f32_bf16 v237, v219, v219, v237
    s_mov_b64 exec, 0xff00ff
    s_cmp_eq_u32 s66, 0
    s_cbranch_scc1 L_X2x_slow
    buffer_store_dwordx2 v[218:219], v28, s[48:51], s63 offen offset:0
L_X2x_back:
    s_mov_b64 exec, -1
    v_permlane16_swap_b32 v236, v237
    v_add_f32 v236, v236, v237
    s_cmp_eq_u32 s66, 0
    s_nop 0
    v_add_f32_dpp v236, v236, v236 quad_perm:[1,0,3,2] row_mask:0xf bank_mask:0xf
    s_nop 1
    v_add_f32_dpp v236, v236, v236 quad_perm:[2,3,0,1] row_mask:0xf bank_mask:0xf
    v_or_b32 v236, 1, v236
    s_mov_b64 exec, 0x110011
    s_cbranch_scc1 L_X2s_slow
    buffer_store_dword v236, v29, s[48:51], 0 offen offset:0
L_X2s_back:
    s_mov_b64 exec, -1
    v_and_b32 v83, 0xffff0000, v217
    v_lshlrev_b32 v82, 16, v217
    v_and_b32 v81, 0xffff0000, v216
    v_lshlrev_b32 v80, 16, v216
    v_mul_f32 v76, 0.5, v80
    v_mul_f32 v77, 0.5, v81
    v_mul_f32 v78, 0.5, v82
    v_mul_f32 v79, 0.5, v83
    s_mov_b32 s64, 1
    s_mov_b32 s65, 1
    s_mov_b64 s[84:85], -1
    s_add_u32 s52, s52, 0x480000
    s_addc_u32 s53, s53, 0
    s_branch L_layer
L_out:
    s_lshl_b32 s80, s57, 11
    s_lshl_b32 s81, s58, 6
    s_add_u32 s80, s80, s81
    s_and_b32 s81, s57, 1
    s_lshl_b32 s81, s81, 2
    s_lshl_b32 s81, 0x000f000f, s81
    s_mov_b32 exec_lo, s81
    s_mov_b32 exec_hi, 0
    buffer_store_dwordx2 v[216:217], v154, s[40:43], s80 offen
    s_cmp_eq_u32 s2, 0
    s_cbranch_scc0 L_noep
    v_mov_b32 v240, s92
    v_mov_b32 v241, s93
    v_mov_b32 v242, 0x228800
    buffer_store_dwordx2 v[240:241], v242, s[48:51], 0 offen
L_noep:
    s_mov_b64 exec, -1
L_fin:
    s_endpgm
L_Q_r:
    s_sub_u32 s67, s67, 1
    s_cbranch_scc1 L_Q_dead
    buffer_load_dwordx2 v[112:113], v18, s[48:51], 0 offen offset:0 sc1
    buffer_load_dwordx4 v[96:99], v17, s[48:51], 0 offen offset:0 sc1
    s_waitcnt vmcnt(0)
    s_branch L_Q_b
L_Q_dead:
    s_mov_b32 s67, 0
    s_branch L_Q_c
L_A_r:
    s_sub_u32 s67, s67, 1
    s_cbranch_scc1 L_A_dead
    v_or3_b32 v15, v96, v97, v98
    v_or_b32 v15, v15, v99
    v_and_b32 v15, 1, v15
    v_cmp_ne_u32 vcc, 0, v15
    s_sleep 1
    s_mov_b64 exec, vcc
    s_cbranch_execz L_Ar_0
    buffer_load_dwordx4 v[96:99], v19, s[52:55], 0 offen offset:0 sc1
L_Ar_0:
    s_mov_b64 exec, -1
    v_or3_b32 v15, v100, v101, v102
    v_or_b32 v15, v15, v103
    v_and_b32 v15, 1, v15
    v_cmp_ne_u32 vcc, 0, v15
    s_nop 0
    s_mov_b64 exec, vcc
    s_cbranch_execz L_Ar_1
    buffer_load_dwordx4 v[100:103], v19, s[52:55], s74 offen offset:0 sc1
L_Ar_1:
    s_mov_b64 exec, -1
    s_waitcnt vmcnt(0)
    s_branch L_A_b
L_A_dead:
    s_mov_b32 s67, 0
    s_branch L_A_c
L_A_l0:
    v_xor_b32 v144, s95, v216
    v_xor_b32 v145, s95, v217
    s_mov_b64 exec, s[4:5]
    buffer_store_dwordx2 v[144:145], v24, s[44:47], s63 offen offset:0 sc1
    s_mov_b64 exec, -1
L_A_l0b:
    s_add_u32 s80, s68, 65536
    s_add_u32 s81, s73, 0
    s_mov_b32 m0, s80
    s_nop 0
    buffer_load_dwordx4 v46, s[12:15], s81 offen nt lds
    s_add_u32 s80, s68, 69632
    s_add_u32 s81, s73, 4096
    s_mov_b32 m0, s80
    s_nop 0
    buffer_load_dwordx4 v46, s[12:15], s81 offen nt lds
    s_add_u32 s80, s68, 73728
    s_add_u32 s81, s73, 8192
    s_mov_b32 m0, s80
    s_nop 0
    buffer_load_dwordx4 v46, s[12:15], s81 offen nt lds
    s_add_u32 s80, s68, 77824
    s_add_u32 s81, s73, 12288
    s_mov_b32 m0, s80
    s_nop 0
    buffer_load_dwordx4 v46, s[12:15], s81 offen nt lds
    s_add_u32 s80, s68, 81920
    s_add_u32 s81, s73, 16384
    s_mov_b32 m0, s80
    s_nop 0
    buffer_load_dwordx4 v46, s[12:15], s81 offen nt lds
    s_add_u32 s80, s68, 86016
    s_add_u32 s81, s73, 20480
    s_mov_b32 m0, s80
    s_nop 0
    buffer_load_dwordx4 v46, s[12:15], s81 offen nt lds
    s_add_u32 s80, s68, 90112
    s_add_u32 s81, s73, 24576
    s_mov_b32 m0, s80
    s_nop 0
    buffer_load_dwordx4 v46, s[12:15], s81 offen nt lds
    s_add_u32 s80, s68, 94208
    s_add_u32 s81, s73, 28672
    s_mov_b32 m0, s80
    s_nop 0
    buffer_load_dwordx4 v46, s[12:15], s81 offen nt lds
    s_mov_b32 s83, 8704
    v_lshlrev_b32 v28, 7, v152
    v_lshl_add_u32 v28, v153, 4, v28
    v_lshl_add_u32 v28, v151, 3, v28
    v_add_u32 v28, 8192, v28
    s_lshl_b32 s80, s57, 11
    s_lshl_b32 s81, s56, 9
    s_add_u32 s81, s81, s80
    s_add_u32 s81, s81, 2244608
    v_lshlrev_b32 v18, 3, v1
    v_add_u32 v18, s81, v18
    v_lshl_add_u32 v5, v3, 1, v150
    s_lshl_b32 s80, s60, 3
    v_add_u32 v5, s80, v5
    v_mul_lo_u32 v22, v5, s83
    v_lshlrev_b32 v6, 6, v153
    v_lshl_add_u32 v6, v152, 4, v6
    s_lshl_b32 s80, s59, 9
    s_add_u32 s80, s80, 2048
    v_add3_u32 v22, v22, v6, s80
    s_lshl_b32 s80, s59, 3
    s_lshl_b32 s81, s56, 1
    s_add_u32 s80, s80, s81
    s_lshl_b32 s80, s80, 3
    s_add_u32 s80, s80, s57
    v_lshl_add_u32 v5, v150, 3, s80
    v_mul_lo_u32 v17, v5, s83
    v_lshlrev_b32 v6, 4, v4
    v_lshl_add_u32 v6, v3, 7, v6
    v_add_u32 v6, 8192, v6
    v_add_u32 v17, v17, v6
    v_lshrrev_b32 v7, 1, v3
    s_lshl_b32 s81, s56, 1
    v_add_u32 v7, s81, v7
    s_lshl_b32 s80, s61, 4
    v_lshl_add_u32 v5, v7, 1, v150
    v_add_u32 v5, s80, v5
    v_and_b32 v6, 7, v5
    v_lshlrev_b32 v6, 2, v6
    s_mov_b32 s80, 0x65437210
    v_lshrrev_b32 v6, v6, s80
    v_and_b32 v6, 7, v6
    v_lshl_add_u32 v6, v6, 2, v151
    v_lshrrev_b32 v5, 3, v5
    v_lshl_add_u32 v5, v6, 3, v5
    v_mul_lo_u32 v19, v5, s83
    s_lshl_b32 s80, s57, 7
    s_add_u32 s80, s80, 0
    v_lshlrev_b32 v6, 4, v4
    v_add3_u32 v19, v19, v6, s80
    s_lshr_b32 s80, s57, 1
    s_lshl_b32 s80, s80, 6
    v_lshl_add_u32 v5, v151, 3, v7
    v_add_u32 v5, s80, v5
    v_mul_lo_u32 v20, v5, s83
    s_lshl_b32 s80, s57, 2
    s_add_u32 s80, s80, s61
    s_and_b32 s81, s80, 7
    s_lshl_b32 s81, s81, 8
    s_add_u32 s81, s81, 6144
    v_lshlrev_b32 v6, 4, v2
    v_add3_u32 v20, v20, v6, s81
    v_bfe_u32 v5, v1, 2, 1
    v_xor_b32 v5, v5, v151
    v_lshl_add_u32 v5, v152, 1, v5
    v_lshl_add_u32 v5, v7, 3, v5
    s_lshl_b32 s80, s80, 9
    s_add_u32 s80, s80, 2228224
    v_lshlrev_b32 v5, 3, v5
    v_add_u32 v21, s80, v5
    v_min_u32 v5, 13, v2
    s_mul_i32 s80, s61, 112
    v_lshl_add_u32 v5, v5, 3, s80
    v_lshrrev_b32 v6, 6, v5
    v_lshl_add_u32 v6, v6, 2, v151
    v_lshl_add_u32 v6, v6, 3, s57
    v_mul_lo_u32 v23, v6, s83
    v_and_b32 v5, 63, v5
    v_lshlrev_b32 v5, 1, v5
    v_lshl_add_u32 v5, v7, 7, v5
    v_add_u32 v5, 1024, v5
    v_add_u32 v23, v23, v5
    v_lshrrev_b32 v8, 1, v3
    v_lshlrev_b32 v5, 4, v3
    s_lshl_b32 s80, s56, 6
    s_add_u32 s80, s80, 6144
    v_lshl_add_u32 v25, v4, 8, v5
    v_add_u32 v25, s80, v25
    s_lshl_b32 s80, s56, 9
    s_add_u32 s80, s80, 2048
    v_lshl_add_u32 v27, v4, 6, v5
    v_add_u32 v27, s80, v27
    s_and_b32 s80, s56, 1
    s_lshl_b32 s80, s80, 6
    v_xor_b32 v38, s80, v32
    s_lshl_b32 s80, s56, 9
    v_add_u32 v38, s80, v38
    v_xor_b32 v5, v7, v4
    v_lshlrev_b32 v5, 4, v5
    v_lshl_add_u32 v5, v2, 7, v5
    v_lshl_add_u32 v5, v151, 3, v5
    v_add_u32 v36, 131072, v5
    v_and_b32 v5, 1, v2
    v_lshl_add_u32 v5, v5, 1, v151
    v_and_b32 v6, 4, v2
    v_xor_b32 v6, v6, v5
    v_xor_b32 v6, v6, v7
    v_lshlrev_b32 v6, 4, v6
    v_lshl_add_u32 v6, v5, 7, v6
    v_lshrrev_b32 v5, 2, v2
    v_lshl_add_u32 v6, v5, 9, v6
    v_bfe_u32 v5, v1, 1, 1
    v_lshl_add_u32 v6, v5, 3, v6
    v_add_u32 v37, 131072, v6
    v_lshlrev_b32 v40, 4, v4
    v_lshl_add_u32 v40, v3, 7, v40
    v_add_u32 v40, 141312, v40
    s_lshl_b32 s80, s56, 2
    v_add_u32 v39, s80, v40
    v_bfe_u32 v5, v1, 2, 2
    v_lshl_add_u32 v6, v151, 2, v5
    v_lshlrev_b32 v6, 1, v6
    s_lshl_b32 s80, s56, 2
    v_add_u32 v9, s80, v152
    v_xor_b32 v6, v9, v6
    v_lshlrev_b32 v6, 4, v6
    v_lshl_add_u32 v9, v3, 2, v5
    v_lshl_add_u32 v42, v9, 8, v6
    v_and_b32 v5, 1, v1
    v_lshlrev_b32 v5, 4, v5
    s_mov_b32 s80, 0xffff
    v_lshlrev_b32 v5, v5, s80
    v_bfe_u32 v6, v1, 1, 2
    v_cmp_eq_u32 vcc, 0, v6
    s_nop 1
    v_cndmask_b32 v52, 0, v5, vcc
    v_and_b32 v60, 0x3f803f80, v52
    v_cmp_eq_u32 vcc, 1, v6
    s_nop 1
    v_cndmask_b32 v53, 0, v5, vcc
    v_and_b32 v61, 0x3f803f80, v53
    v_cmp_eq_u32 vcc, 2, v6
    s_nop 1
    v_cndmask_b32 v54, 0, v5, vcc
    v_and_b32 v62, 0x3f803f80, v54
    v_cmp_eq_u32 vcc, 3, v6
    s_nop 1
    v_cndmask_b32 v55, 0, v5, vcc
    v_and_b32 v63, 0x3f803f80, v55
    v_cmp_eq_u32 vcc, v150, v8
    s_nop 1
    v_cndmask_b32 v52, 0, v52, vcc
    v_and_b32 v56, 0x3f803f80, v52
    v_cndmask_b32 v53, 0, v53, vcc
    v_and_b32 v57, 0x3f803f80, v53
    v_cndmask_b32 v54, 0, v54, vcc
    v_and_b32 v58, 0x3f803f80, v54
    v_cndmask_b32 v55, 0, v55, vcc
    v_and_b32 v59, 0x3f803f80, v55
    v_lshlrev_b32 v148, 5, v1
    v_add_u32 v148, 0x228000, v148
    v_lshlrev_b32 v13, 7, v1
    v_add_u32 v14, 1024, v13
    v_add_u32 v15, 7168, v13
    v_cmp_gt_u32 vcc, 8, v1
    s_nop 1
    v_cndmask_b32 v14, v15, v14, vcc
    v_add_u32 v14, s63, v14
    v_cmp_gt_u32 vcc, 12, v1
    s_nop 1
    v_cndmask_b32 v149, v29, v14, vcc
    s_waitcnt vmcnt(10)
    s_barrier
    s_lshl_b32 s80, s56, 13
    v_xor_b32 v5, v3, v2
    v_lshlrev_b32 v5, 4, v5
    v_lshl_add_u32 v5, v2, 8, v5
    v_add_u32 v7, s80, v5
    v_xor_b32 v8, 64, v7
    v_xor_b32 v9, 128, v7
    v_xor_b32 v10, 192, v7
    ds_read_b128 a[32:35], v7 offset:32768
    ds_read_b128 a[36:39], v8 offset:32768
    ds_read_b128 a[40:43], v9 offset:32768
    ds_read_b128 a[44:47], v10 offset:32768
    ds_read_b128 a[48:51], v7 offset:36864
    ds_read_b128 a[52:55], v8 offset:36864
    ds_read_b128 a[56:59], v9 offset:36864
    ds_read_b128 a[60:63], v10 offset:36864
    s_waitcnt vmcnt(0)
    buffer_load_dwordx4 v[96:99], v19, s[52:55], 0 offen offset:0 sc1
    buffer_load_dwordx4 v[100:103], v19, s[52:55], s74 offen offset:0 sc1
    buffer_load_dwordx4 v[116:119], v19, s[44:47], 0 offen offset:0 sc1
    buffer_load_dwordx4 v[120:123], v19, s[44:47], s74 offen offset:0 sc1
    buffer_load_dwordx4 v[136:139], v148, s[48:51], 0 offen sc1
    buffer_load_dwordx4 v[140:143], v148, s[48:51], 0 offen offset:16 sc1
    s_waitcnt vmcnt(0)
L_A_k0:
    v_bitop3_b32 v15, v96, v116, s95 bitop3:0x96
    v_bitop3_b32 v14, v97, v117, s95 bitop3:0x96
    v_or_b32 v16, v15, v14
    v_bitop3_b32 v15, v98, v118, s95 bitop3:0x96
    v_bitop3_b32 v14, v99, v119, s95 bitop3:0x96
    v_or3_b32 v16, v16, v15, v14
    v_bitop3_b32 v15, v100, v120, s95 bitop3:0x96
    v_bitop3_b32 v14, v101, v121, s95 bitop3:0x96
    v_or3_b32 v16, v16, v15, v14
    v_bitop3_b32 v15, v102, v122, s95 bitop3:0x96
    v_bitop3_b32 v14, v103, v123, s95 bitop3:0x96
    v_or3_b32 v16, v16, v15, v14
    s_not_b32 s80, s95
    v_xor_b32 v5, s80, v137
    v_xor_b32 v6, s80, v139
    v_xor_b32 v7, s80, v141
    v_xor_b32 v8, s80, v143
    v_or3_b32 v9, v5, v6, v7
    v_or_b32 v9, v9, v8
    v_and_or_b32 v16, v9, -16, v16
    v_bitop3_b32 v16, v16, v136, s95 bitop3:0xf6
    v_bitop3_b32 v16, v16, v138, s95 bitop3:0xf6
    v_bitop3_b32 v16, v16, v140, s95 bitop3:0xf6
    v_bitop3_b32 v16, v16, v142, s95 bitop3:0xf6
    v_cmp_ne_u32 vcc, 0, v16
    s_cbranch_vccz L_A_ok0
    s_sub_u32 s67, s67, 1
    s_cbranch_scc1 L_A_dead0
    s_sleep 1
    buffer_load_dwordx4 v[96:99], v19, s[52:55], 0 offen offset:0 sc1
    buffer_load_dwordx4 v[100:103], v19, s[52:55], s74 offen offset:0 sc1
    buffer_load_dwordx4 v[116:119], v19, s[44:47], 0 offen offset:0 sc1
    buffer_load_dwordx4 v[120:123], v19, s[44:47], s74 offen offset:0 sc1
    buffer_load_dwordx4 v[136:139], v148, s[48:51], 0 offen sc1
    buffer_load_dwordx4 v[140:143], v148, s[48:51], 0 offen offset:16 sc1
L_A_w0:
    s_waitcnt vmcnt(0)
    s_branch L_A_k0
L_A_dead0:
    s_mov_b32 s67, 0
L_A_ok0:
    s_and_b32 s80, s57, 3
    s_cmp_eq_u32 s80, 1
    s_cselect_b64 vcc, -1, 0
    v_cndmask_b32 v5, v5, v6, vcc
    s_cmp_eq_u32 s80, 2
    s_cselect_b64 vcc, -1, 0
    v_cndmask_b32 v5, v5, v7, vcc
    s_cmp_eq_u32 s80, 3
    s_cselect_b64 vcc, -1, 0
    v_cndmask_b32 v5, v5, v8, vcc
    v_cmp_ne_u32 vcc, s94, v5
    s_lshr_b32 s80, s57, 2
    s_lshl_b32 s80, 0x55555555, s80
    s_or_b32 s81, vcc_lo, vcc_hi
    s_and_b32 s81, s81, s80
    s_cselect_b32 s66, 0, 1
    s_cmp_eq_u32 s56, 0
    s_cbranch_scc0 L_notouch
    s_mov_b64 exec, 0x1fff
    buffer_load_dword v132, v149, s[48:51], 0 offen sc1
    s_mov_b64 exec, -1
L_notouch:
    s_add_u32 s80, s68, 98304
    s_add_u32 s81, s71, 0
    s_mov_b32 m0, s80
    s_nop 0
    buffer_load_dwordx4 v45, s[20:23], s81 offen nt lds
    s_add_u32 s80, s68, 102400
    s_add_u32 s81, s71, 32768
    s_mov_b32 m0, s80
    s_nop 0
    buffer_load_dwordx4 v45, s[20:23], s81 offen nt lds
    s_add_u32 s80, s68, 106496
    s_add_u32 s81, s71, 65536
    s_mov_b32 m0, s80
    s_nop 0
    buffer_load_dwordx4 v45, s[20:23], s81 offen nt lds
    s_add_u32 s80, s68, 110592
    s_add_u32 s81, s71, 98304
    s_mov_b32 m0, s80
    s_nop 0
    buffer_load_dwordx4 v45, s[20:23], s81 offen nt lds
    s_add_u32 s80, s68, 114688
    s_add_u32 s81, s71, 131072
    s_mov_b32 m0, s80
    s_nop 0
    buffer_load_dwordx4 v45, s[20:23], s81 offen nt lds
    s_add_u32 s80, s68, 118784
    s_add_u32 s81, s71, 163840
    s_mov_b32 m0, s80
    s_nop 0
    buffer_load_dwordx4 v45, s[20:23], s81 offen nt lds
    s_barrier
    v_add_u32 v5, 65536, v42
    ds_read_b64_tr_b16 a[64:65], v5 offset:0
    ds_read_b64_tr_b16 a[66:67], v5 offset:4096
    ds_read_b64_tr_b16 a[68:69], v5 offset:8192
    ds_read_b64_tr_b16 a[70:71], v5 offset:12288
    ds_read_b64_tr_b16 a[72:73], v5 offset:16384
    ds_read_b64_tr_b16 a[74:75], v5 offset:20480
    ds_read_b64_tr_b16 a[76:77], v5 offset:24576
    ds_read_b64_tr_b16 a[78:79], v5 offset:28672
    ds_read_b64_tr_b16 a[80:81], v5 offset:8
    ds_read_b64_tr_b16 a[82:83], v5 offset:4104
    ds_read_b64_tr_b16 a[84:85], v5 offset:8200
    ds_read_b64_tr_b16 a[86:87], v5 offset:12296
    ds_read_b64_tr_b16 a[88:89], v5 offset:16392
    ds_read_b64_tr_b16 a[90:91], v5 offset:20488
    ds_read_b64_tr_b16 a[92:93], v5 offset:24584
    ds_read_b64_tr_b16 a[94:95], v5 offset:28680
    s_branch L_A_b
L_O_r:
    s_sub_u32 s67, s67, 1
    s_cbranch_scc1 L_O_dead
    v_or_b32 v15, v112, v113
    v_and_b32 v15, 1, v15
    v_cmp_ne_u32 vcc, 0, v15
    s_sleep 1
    s_mov_b64 exec, vcc
    s_cbranch_execz L_Or_0
    buffer_load_dwordx2 v[112:113], v21, s[52:55], 0 offen offset:0 sc1
L_Or_0:
    s_mov_b64 exec, -1
    v_or3_b32 v15, v96, v97, v98
    v_or_b32 v15, v15, v99
    v_and_b32 v15, 1, v15
    v_cmp_ne_u32 vcc, 0, v15
    s_nop 0
    s_mov_b64 exec, vcc
    s_cbranch_execz L_Or_1
    buffer_load_dwordx4 v[96:99], v20, s[52:55], 0 offen offset:0 sc1
L_Or_1:
    s_mov_b64 exec, -1
    v_or3_b32 v15, v100, v101, v102
    v_or_b32 v15, v15, v103
    v_and_b32 v15, 1, v15
    v_cmp_ne_u32 vcc, 0, v15
    s_nop 0
    s_mov_b64 exec, vcc
    s_cbranch_execz L_Or_2
    buffer_load_dwordx4 v[100:103], v20, s[52:55], s74 offen offset:0 sc1
L_Or_2:
    s_mov_b64 exec, -1
    v_or3_b32 v15, v104, v105, v106
    v_or_b32 v15, v15, v107
    v_and_b32 v15, 1, v15
    v_cmp_ne_u32 vcc, 0, v15
    s_nop 0
    s_mov_b64 exec, vcc
    s_cbranch_execz L_Or_3
    buffer_load_dwordx4 v[104:107], v20, s[52:55], s75 offen offset:0 sc1
L_Or_3:
    s_mov_b64 exec, -1
    v_or3_b32 v15, v108, v109, v110
    v_or_b32 v15, v15, v111
    v_and_b32 v15, 1, v15
    v_cmp_ne_u32 vcc, 0, v15
    s_nop 0
    s_mov_b64 exec, vcc
    s_cbranch_execz L_Or_4
    buffer_load_dwordx4 v[108:111], v20, s[52:55], s76 offen offset:0 sc1
L_Or_4:
    s_mov_b64 exec, -1
    s_waitcnt vmcnt(0)
    s_branch L_O_b
L_O_dead:
    s_mov_b32 s67, 0
    s_branch L_O_c
L_O_l0:
L_O_l0b:
    s_add_u32 s80, s68, 122880
    s_add_u32 s81, s71, 196608
    s_mov_b32 m0, s80
    s_nop 0
    buffer_load_dwordx4 v45, s[20:23], s81 offen nt lds
    s_add_u32 s80, s68, 126976
    s_add_u32 s81, s71, 229376
    s_mov_b32 m0, s80
    s_nop 0
    buffer_load_dwordx4 v45, s[20:23], s81 offen nt lds
    s_cmp_lt_u32 s58, 28
    s_cbranch_scc0 L_now1_1
    s_add_u32 s80, s68, 0
    s_add_u32 s81, s70, 0
    s_mov_b32 m0, s80
    s_nop 0
    buffer_load_dwordx4 v44, s[24:27], s81 offen nt lds
    s_add_u32 s80, s68, 4096
    s_add_u32 s81, s70, 229376
    s_mov_b32 m0, s80
    s_nop 0
    buffer_load_dwordx4 v44, s[24:27], s81 offen nt lds
    s_add_u32 s80, s68, 8192
    s_add_u32 s81, s70, 458752
    s_mov_b32 m0, s80
    s_nop 0
    buffer_load_dwordx4 v44, s[24:27], s81 offen nt lds
L_now1_1:
    s_sleep 24
    buffer_load_dwordx2 v[112:113], v21, s[52:55], 0 offen offset:0 sc1
    buffer_load_dwordx4 v[96:99], v20, s[52:55], 0 offen offset:0 sc1
    buffer_load_dwordx4 v[100:103], v20, s[52:55], s74 offen offset:0 sc1
    buffer_load_dwordx4 v[104:107], v20, s[52:55], s75 offen offset:0 sc1
    buffer_load_dwordx4 v[108:111], v20, s[52:55], s76 offen offset:0 sc1
    s_waitcnt vmcnt(0)
L_O_k0:
    v_bitop3_b32 v16, v112, v113, v96 bitop3:0xfe
    v_bitop3_b32 v16, v16, v97, v98 bitop3:0xfe
    v_bitop3_b32 v16, v16, v99, v100 bitop3:0xfe
    v_bitop3_b32 v16, v16, v101, v102 bitop3:0xfe
    v_bitop3_b32 v16, v16, v103, v104 bitop3:0xfe
    v_bitop3_b32 v16, v16, v105, v106 bitop3:0xfe
    v_bitop3_b32 v16, v16, v107, v108 bitop3:0xfe
    v_bitop3_b32 v16, v16, v109, v110 bitop3:0xfe
    v_bitop3_b32 v16, v16, v111, v111 bitop3:0xfe
    v_and_b32 v16, 1, v16
    v_cmp_ne_u32 vcc, 0, v16
    s_cbranch_vccz L_O_ok0
    s_sub_u32 s67, s67, 1
    s_cbranch_scc1 L_O_dead0
    v_or_b32 v15, v112, v113
    v_and_b32 v15, 1, v15
    v_cmp_ne_u32 vcc, 0, v15
    s_sleep 1
    s_mov_b64 exec, vcc
    s_cbranch_execz L_Or0_0
    buffer_load_dwordx2 v[112:113], v21, s[52:55], 0 offen offset:0 sc1
L_Or0_0:
    s_mov_b64 exec, -1
    v_or3_b32 v15, v96, v97, v98
    v_or_b32 v15, v15, v99
    v_and_b32 v15, 1, v15
    v_cmp_ne_u32 vcc, 0, v15
    s_nop 0
    s_mov_b64 exec, vcc
    s_cbranch_execz L_Or0_1
    buffer_load_dwordx4 v[96:99], v20, s[52:55], 0 offen offset:0 sc1
L_Or0_1:
    s_mov_b64 exec, -1
    v_or3_b32 v15, v100, v101, v102
    v_or_b32 v15, v15, v103
    v_and_b32 v15, 1, v15
    v_cmp_ne_u32 vcc, 0, v15
    s_nop 0
    s_mov_b64 exec, vcc
    s_cbranch_execz L_Or0_2
    buffer_load_dwordx4 v[100:103], v20, s[52:55], s74 offen offset:0 sc1
L_Or0_2:
    s_mov_b64 exec, -1
    v_or3_b32 v15, v104, v105, v106
    v_or_b32 v15, v15, v107
    v_and_b32 v15, 1, v15
    v_cmp_ne_u32 vcc, 0, v15
    s_nop 0
    s_mov_b64 exec, vcc
    s_cbranch_execz L_Or0_3
    buffer_load_dwordx4 v[104:107], v20, s[52:55], s75 offen offset:0 sc1
L_Or0_3:
    s_mov_b64 exec, -1
    v_or3_b32 v15, v108, v109, v110
    v_or_b32 v15, v15, v111
    v_and_b32 v15, 1, v15
    v_cmp_ne_u32 vcc, 0, v15
    s_nop 0
    s_mov_b64 exec, vcc
    s_cbranch_execz L_Or0_4
    buffer_load_dwordx4 v[108:111], v20, s[52:55], s76 offen offset:0 sc1
L_Or0_4:
    s_mov_b64 exec, -1
L_O_w0:
    s_waitcnt vmcnt(0)
    s_branch L_O_k0
L_O_dead0:
    s_mov_b32 s67, 0
L_O_ok0:
    s_barrier
    s_cmp_lt_u32 s58, 28
    s_cbranch_scc0 L_now1_2
    s_add_u32 s80, s68, 12288
    s_add_u32 s81, s70, 688128
    s_mov_b32 m0, s80
    s_nop 0
    buffer_load_dwordx4 v44, s[24:27], s81 offen nt lds
    s_add_u32 s80, s68, 16384
    s_add_u32 s81, s70, 917504
    s_mov_b32 m0, s80
    s_nop 0
    buffer_load_dwordx4 v44, s[24:27], s81 offen nt lds
    s_add_u32 s80, s68, 20480
    s_add_u32 s81, s70, 1146880
    s_mov_b32 m0, s80
    s_nop 0
    buffer_load_dwordx4 v44, s[24:27], s81 offen nt lds
    s_add_u32 s80, s68, 24576
    s_add_u32 s81, s70, 1376256
    s_mov_b32 m0, s80
    s_nop 0
    buffer_load_dwordx4 v44, s[24:27], s81 offen nt lds
    s_add_u32 s80, s68, 28672
    s_add_u32 s81, s70, 1605632
    s_mov_b32 m0, s80
    s_nop 0
    buffer_load_dwordx4 v44, s[24:27], s81 offen nt lds
L_now1_2:
    s_add_u32 s80, s68, 32768
    s_add_u32 s81, s72, 0
    s_mov_b32 m0, s80
    s_nop 0
    buffer_load_dwordx4 v45, s[32:35], s81 offen nt lds
    v_add_u32 v5, 98304, v42
    ds_read_b64_tr_b16 a[96:97], v5 offset:0
    ds_read_b64_tr_b16 a[98:99], v5 offset:4096
    ds_read_b64_tr_b16 a[100:101], v5 offset:8192
    ds_read_b64_tr_b16 a[102:103], v5 offset:12288
    ds_read_b64_tr_b16 a[104:105], v5 offset:16384
    ds_read_b64_tr_b16 a[106:107], v5 offset:20480
    ds_read_b64_tr_b16 a[108:109], v5 offset:24576
    ds_read_b64_tr_b16 a[110:111], v5 offset:28672
    ds_read_b64_tr_b16 a[112:113], v5 offset:8
    ds_read_b64_tr_b16 a[114:115], v5 offset:4104
    ds_read_b64_tr_b16 a[116:117], v5 offset:8200
    ds_read_b64_tr_b16 a[118:119], v5 offset:12296
    ds_read_b64_tr_b16 a[120:121], v5 offset:16392
    ds_read_b64_tr_b16 a[122:123], v5 offset:20488
    ds_read_b64_tr_b16 a[124:125], v5 offset:24584
    ds_read_b64_tr_b16 a[126:127], v5 offset:28680
    s_branch L_O_b
L_X1_r:
    s_sub_u32 s67, s67, 1
    s_cbranch_scc1 L_X1_dead
    v_or3_b32 v15, v96, v97, v98
    v_or_b32 v15, v15, v99
    v_and_b32 v15, 1, v15
    v_cmp_ne_u32 vcc, 0, v15
    s_sleep 1
    s_mov_b64 exec, vcc
    s_cbranch_execz L_X1r_0
    buffer_load_dwordx4 v[96:99], v22, s[52:55], 0 offen offset:0 sc1
L_X1r_0:
    s_mov_b64 exec, -1
    v_or3_b32 v15, v100, v101, v102
    v_or_b32 v15, v15, v103
    v_and_b32 v15, 1, v15
    v_cmp_ne_u32 vcc, 0, v15
    s_nop 0
    s_mov_b64 exec, vcc
    s_cbranch_execz L_X1r_1
    buffer_load_dwordx4 v[100:103], v22, s[52:55], s77 offen offset:0 sc1
L_X1r_1:
    s_mov_b64 exec, -1
    v_or3_b32 v15, v104, v105, v106
    v_or_b32 v15, v15, v107
    v_and_b32 v15, 1, v15
    v_cmp_ne_u32 vcc, 0, v15
    s_nop 0
    s_mov_b64 exec, vcc
    s_cbranch_execz L_X1r_2
    buffer_load_dwordx4 v[104:107], v22, s[52:55], s78 offen offset:0 sc1
L_X1r_2:
    s_mov_b64 exec, -1
    v_or3_b32 v15, v108, v109, v110
    v_or_b32 v15, v15, v111
    v_and_b32 v15, 1, v15
    v_cmp_ne_u32 vcc, 0, v15
    s_nop 0
    s_mov_b64 exec, vcc
    s_cbranch_execz L_X1r_3
    buffer_load_dwordx4 v[108:111], v22, s[52:55], s79 offen offset:0 sc1
L_X1r_3:
    s_mov_b64 exec, -1
    s_waitcnt vmcnt(0)
    s_branch L_X1_b
L_X1_dead:
    s_mov_b32 s67, 0
    s_branch L_X1_c
L_X1_l0:
L_X1_l0b:
    s_cmp_lt_u32 s58, 28
    s_cbranch_scc0 L_now1f
    s_sleep 16
    s_waitcnt vmcnt(2)
    s_barrier
    ds_read_b64_tr_b16 a[128:129], v41 offset:0
    ds_read_b64_tr_b16 a[130:131], v41 offset:512
    ds_read_b64_tr_b16 a[132:133], v41 offset:4096
    ds_read_b64_tr_b16 a[134:135], v41 offset:4608
    ds_read_b64_tr_b16 a[136:137], v41 offset:8192
    ds_read_b64_tr_b16 a[138:139], v41 offset:8704
    ds_read_b64_tr_b16 a[140:141], v41 offset:12288
    ds_read_b64_tr_b16 a[142:143], v41 offset:12800
    ds_read_b64_tr_b16 a[144:145], v41 offset:16384
    ds_read_b64_tr_b16 a[146:147], v41 offset:16896
    ds_read_b64_tr_b16 a[148:149], v41 offset:20480
    ds_read_b64_tr_b16 a[150:151], v41 offset:20992
    ds_read_b64_tr_b16 a[152:153], v41 offset:24576
    ds_read_b64_tr_b16 a[154:155], v41 offset:25088
    ds_read_b64_tr_b16 a[156:157], v41 offset:28672
    ds_read_b64_tr_b16 a[158:159], v41 offset:29184
    s_waitcnt lgkmcnt(0)
    v_mfma_f32_16x16x32_bf16 v[72:75], a[128:131], v[64:67], 0
    v_mfma_f32_16x16x32_bf16 v[72:75], a[132:135], v[64:67], v[72:75]
    v_mfma_f32_16x16x32_bf16 v[72:75], a[136:139], v[64:67], v[72:75]
    v_mfma_f32_16x16x32_bf16 v[72:75], a[140:143], v[64:67], v[72:75]
    v_mfma_f32_16x16x32_bf16 v[72:75], a[144:147], v[64:67], v[72:75]
    v_mfma_f32_16x16x32_bf16 v[72:75], a[148:151], v[64:67], v[72:75]
    v_mfma_f32_16x16x32_bf16 v[72:75], a[152:155], v[64:67], v[72:75]
    v_mfma_f32_16x16x32_bf16 v[72:75], a[156:159], v[64:67], v[72:75]
    s_branch L_w1f
L_now1f:
    s_sleep 20
L_w1f:
    s_sleep 4
    buffer_load_dwordx4 v[96:99], v22, s[52:55], 0 offen offset:0 sc1
    buffer_load_dwordx4 v[100:103], v22, s[52:55], s77 offen offset:0 sc1
    buffer_load_dwordx4 v[104:107], v22, s[52:55], s78 offen offset:0 sc1
    buffer_load_dwordx4 v[108:111], v22, s[52:55], s79 offen offset:0 sc1
    s_add_u32 s80, s68, 36864
    s_add_u32 s81, s72, 32768
    s_mov_b32 m0, s80
    s_nop 0
    buffer_load_dwordx4 v45, s[32:35], s81 offen nt lds
    s_add_u32 s80, s68, 40960
    s_add_u32 s81, s72, 65536
    s_mov_b32 m0, s80
    s_nop 0
    buffer_load_dwordx4 v45, s[32:35], s81 offen nt lds
    s_add_u32 s80, s68, 45056
    s_add_u32 s81, s72, 98304
    s_mov_b32 m0, s80
    s_nop 0
    buffer_load_dwordx4 v45, s[32:35], s81 offen nt lds
    s_add_u32 s80, s68, 49152
    s_add_u32 s81, s72, 131072
    s_mov_b32 m0, s80
    s_nop 0
    buffer_load_dwordx4 v45, s[32:35], s81 offen nt lds
    s_add_u32 s80, s68, 53248
    s_add_u32 s81, s72, 163840
    s_mov_b32 m0, s80
    s_nop 0
    buffer_load_dwordx4 v45, s[32:35], s81 offen nt lds
    s_add_u32 s80, s68, 57344
    s_add_u32 s81, s72, 196608
    s_mov_b32 m0, s80
    s_nop 0
    buffer_load_dwordx4 v45, s[32:35], s81 offen nt lds
    s_waitcnt vmcnt(6)
L_X1_k0:
    v_bitop3_b32 v16, v96, v97, v98 bitop3:0xfe
    v_bitop3_b32 v16, v16, v99, v100 bitop3:0xfe
    v_bitop3_b32 v16, v16, v101, v102 bitop3:0xfe
    v_bitop3_b32 v16, v16, v103, v104 bitop3:0xfe
    v_bitop3_b32 v16, v16, v105, v106 bitop3:0xfe
    v_bitop3_b32 v16, v16, v107, v108 bitop3:0xfe
    v_bitop3_b32 v16, v16, v109, v110 bitop3:0xfe
    v_bitop3_b32 v16, v16, v111, v111 bitop3:0xfe
    v_and_b32 v16, 1, v16
    v_cmp_ne_u32 vcc, 0, v16
    s_cbranch_vccz L_X1_ok0
    s_sub_u32 s67, s67, 1
    s_cbranch_scc1 L_X1_dead0
    v_or3_b32 v15, v96, v97, v98
    v_or_b32 v15, v15, v99
    v_and_b32 v15, 1, v15
    v_cmp_ne_u32 vcc, 0, v15
    s_sleep 1
    s_mov_b64 exec, vcc
    s_cbranch_execz L_X1r0_0
    buffer_load_dwordx4 v[96:99], v22, s[52:55], 0 offen offset:0 sc1
L_X1r0_0:
    s_mov_b64 exec, -1
    v_or3_b32 v15, v100, v101, v102
    v_or_b32 v15, v15, v103
    v_and_b32 v15, 1, v15
    v_cmp_ne_u32 vcc, 0, v15
    s_nop 0
    s_mov_b64 exec, vcc
    s_cbranch_execz L_X1r0_1
    buffer_load_dwordx4 v[100:103], v22, s[52:55], s77 offen offset:0 sc1
L_X1r0_1:
    s_mov_b64 exec, -1
    v_or3_b32 v15, v104, v105, v106
    v_or_b32 v15, v15, v107
    v_and_b32 v15, 1, v15
    v_cmp_ne_u32 vcc, 0, v15
    s_nop 0
    s_mov_b64 exec, vcc
    s_cbranch_execz L_X1r0_2
    buffer_load_dwordx4 v[104:107], v22, s[52:55], s78 offen offset:0 sc1
L_X1r0_2:
    s_mov_b64 exec, -1
    v_or3_b32 v15, v108, v109, v110
    v_or_b32 v15, v15, v111
    v_and_b32 v15, 1, v15
    v_cmp_ne_u32 vcc, 0, v15
    s_nop 0
    s_mov_b64 exec, vcc
    s_cbranch_execz L_X1r0_3
    buffer_load_dwordx4 v[108:111], v22, s[52:55], s79 offen offset:0 sc1
L_X1r0_3:
    s_mov_b64 exec, -1
L_X1_w0:
    s_waitcnt vmcnt(0)
    s_branch L_X1_k0
L_X1_dead0:
    s_mov_b32 s67, 0
L_X1_ok0:
    s_branch L_X1_b
L_X1x_slow:
    buffer_store_dwordx2 v[218:219], v28, s[48:51], s63 offen offset:0 sc1
    s_branch L_X1x_back
L_X1s_slow:
    buffer_store_dword v236, v29, s[48:51], 0 offen offset:0 sc1
    s_branch L_X1s_back
L_skipM:
    s_cmp_eq_u32 s64, 0
    s_cbranch_scc1 L_skipM0
    s_sleep 12
    s_branch L_M2
L_skipM0:
    v_mov_b32 v220, -1
    v_mov_b32 v221, -1
    v_mov_b32 v222, -1
    v_mov_b32 v223, -1
    v_lshlrev_b32 v6, 4, v1
    s_lshl_b32 s80, s56, 11
    s_add_u32 s80, s80, s63
    s_add_u32 s80, s80, 0x480000
    s_cmp_eq_u32 s56, 3
    s_cbranch_scc1 L_clr13b
    buffer_store_dwordx4 v[220:223], v6, s[48:51], s80 offen offset:2048 sc1
    buffer_store_dwordx4 v[220:223], v6, s[48:51], s80 offen offset:3072 sc1
    s_branch L_clr1db
L_clr13b:
    s_add_u32 s80, s63, 0x480000
    buffer_store_dwordx4 v[220:223], v6, s[48:51], s80 offen offset:0 sc1
    s_mov_b64 exec, 0xff
    s_mov_b32 s80, 0x480000
    buffer_store_dwordx2 v[220:221], v26, s[48:51], s80 offen sc1
    s_mov_b64 exec, -1
L_clr1db:
    s_sleep 16
    s_branch L_H_l0b
L_M_r:
    s_sub_u32 s67, s67, 1
    s_cbranch_scc1 L_M_dead
    buffer_load_dwordx2 v[112:113], v18, s[48:51], 0 offen offset:0 sc1
    buffer_load_dwordx4 v[96:99], v17, s[48:51], 0 offen offset:0 sc1
    s_waitcnt vmcnt(0)
    s_branch L_M_b
L_M_dead:
    s_mov_b32 s67, 0
    s_branch L_M_c
L_M_l0:
L_M_l0b:
    s_sleep 5
    buffer_load_dwordx2 v[112:113], v18, s[48:51], 0 offen offset:0 sc1
    buffer_load_dwordx4 v[96:99], v17, s[48:51], 0 offen offset:0 sc1
    s_waitcnt vmcnt(0)
L_M_k0:
    v_bitop3_b32 v16, v112, v113, v96 bitop3:0xfe
    v_bitop3_b32 v16, v16, v97, v98 bitop3:0xfe
    v_bitop3_b32 v16, v16, v99, v99 bitop3:0xfe
    v_and_b32 v16, 1, v16
    v_cmp_ne_u32 vcc, 0, v16
    s_cbranch_vccz L_M_ok0
    s_sub_u32 s67, s67, 1
    s_cbranch_scc1 L_M_dead0
    buffer_load_dwordx2 v[112:113], v18, s[48:51], 0 offen offset:0 sc1
    buffer_load_dwordx4 v[96:99], v17, s[48:51], 0 offen offset:0 sc1
L_M_w0:
    s_waitcnt vmcnt(0)
    s_branch L_M_k0
L_M_dead0:
    s_mov_b32 s67, 0
L_M_ok0:
    v_mov_b32 v220, -1
    v_mov_b32 v221, -1
    v_mov_b32 v222, -1
    v_mov_b32 v223, -1
    v_lshlrev_b32 v6, 4, v1
    s_lshl_b32 s80, s56, 11
    s_add_u32 s80, s80, s63
    s_add_u32 s80, s80, 0x480000
    s_cmp_eq_u32 s56, 3
    s_cbranch_scc1 L_clr13a
    buffer_store_dwordx4 v[220:223], v6, s[48:51], s80 offen offset:2048 sc1
    buffer_store_dwordx4 v[220:223], v6, s[48:51], s80 offen offset:3072 sc1
    s_branch L_clr1da
L_clr13a:
    s_add_u32 s80, s63, 0x480000
    buffer_store_dwordx4 v[220:223], v6, s[48:51], s80 offen offset:0 sc1
    s_mov_b64 exec, 0xff
    s_mov_b32 s80, 0x480000
    buffer_store_dwordx2 v[220:221], v26, s[48:51], s80 offen sc1
    s_mov_b64 exec, -1
L_clr1da:
    s_branch L_M_b
L_Mp_slow:
    buffer_store_dwordx2 v[216:217], v24, s[48:51], s63 offen offset:1024 sc1
    s_branch L_Mp_back
L_H_r:
    s_sub_u32 s67, s67, 1
    s_cbranch_scc1 L_H_dead
    buffer_load_dwordx4 v[96:99], v23, s[48:51], 0 offen offset:0 sc1
    buffer_load_dwordx4 v[100:103], v23, s[48:51], s74 offen offset:0 sc1
    s_waitcnt vmcnt(0)
    s_branch L_H_b
L_H_dead:
    s_mov_b32 s67, 0
    s_branch L_H_c
L_H_l0:
L_H_l0b:
    s_sleep 6
    buffer_load_dwordx4 v[96:99], v23, s[48:51], 0 offen offset:0 sc1
    buffer_load_dwordx4 v[100:103], v23, s[48:51], s74 offen offset:0 sc1
    s_waitcnt vmcnt(0)
L_H_k0:
    v_bitop3_b32 v16, v96, v97, v98 bitop3:0xfe
    v_bitop3_b32 v16, v16, v99, v100 bitop3:0xfe
    v_bitop3_b32 v16, v16, v101, v102 bitop3:0xfe
    v_bitop3_b32 v16, v16, v103, v103 bitop3:0xfe
    v_and_b32 v16, 1, v16
    v_cmp_ne_u32 vcc, 0, v16
    s_cbranch_vccz L_H_ok0
    s_sub_u32 s67, s67, 1
    s_cbranch_scc1 L_H_dead0
    buffer_load_dwordx4 v[96:99], v23, s[48:51], 0 offen offset:0 sc1
    buffer_load_dwordx4 v[100:103], v23, s[48:51], s74 offen offset:0 sc1
L_H_w0:
    s_waitcnt vmcnt(0)
    s_branch L_H_k0
L_H_dead0:
    s_mov_b32 s67, 0
L_H_ok0:
    s_barrier
    v_add_u32 v5, 32768, v42
    ds_read_b64_tr_b16 a[160:161], v5 offset:0
    ds_read_b64_tr_b16 a[162:163], v5 offset:4096
    ds_read_b64_tr_b16 a[164:165], v5 offset:8192
    ds_read_b64_tr_b16 a[166:167], v5 offset:12288
    ds_read_b64_tr_b16 a[168:169], v5 offset:16384
    ds_read_b64_tr_b16 a[170:171], v5 offset:20480
    ds_read_b64_tr_b16 a[172:173], v5 offset:24576
    ds_read_b64_tr_b16 a[176:177], v5 offset:8
    ds_read_b64_tr_b16 a[178:179], v5 offset:4104
    ds_read_b64_tr_b16 a[180:181], v5 offset:8200
    ds_read_b64_tr_b16 a[182:183], v5 offset:12296
    ds_read_b64_tr_b16 a[184:185], v5 offset:16392
    ds_read_b64_tr_b16 a[186:187], v5 offset:20488
    ds_read_b64_tr_b16 a[188:189], v5 offset:24584
    s_branch L_H_b
L_X2_r:
    s_sub_u32 s67, s67, 1
    s_cbranch_scc1 L_X2_dead
    v_or3_b32 v15, v96, v97, v98
    v_or_b32 v15, v15, v99
    v_and_b32 v15, 1, v15
    v_cmp_ne_u32 vcc, 0, v15
    s_sleep 1
    s_mov_b64 exec, vcc
    s_cbranch_execz L_X2r_0
    buffer_load_dwordx4 v[96:99], v22, s[52:55], 0 offen offset:2048 sc1
L_X2r_0:
    s_mov_b64 exec, -1
    v_or3_b32 v15, v100, v101, v102
    v_or_b32 v15, v15, v103
    v_and_b32 v15, 1, v15
    v_cmp_ne_u32 vcc, 0, v15
    s_nop 0
    s_mov_b64 exec, vcc
    s_cbranch_execz L_X2r_1
    buffer_load_dwordx4 v[100:103], v22, s[52:55], s77 offen offset:2048 sc1
L_X2r_1:
    s_mov_b64 exec, -1
    v_or3_b32 v15, v104, v105, v106
    v_or_b32 v15, v15, v107
    v_and_b32 v15, 1, v15
    v_cmp_ne_u32 vcc, 0, v15
    s_nop 0
    s_mov_b64 exec, vcc
    s_cbranch_execz L_X2r_2
    buffer_load_dwordx4 v[104:107], v22, s[52:55], s78 offen offset:2048 sc1
L_X2r_2:
    s_mov_b64 exec, -1
    v_or3_b32 v15, v108, v109, v110
    v_or_b32 v15, v15, v111
    v_and_b32 v15, 1, v15
    v_cmp_ne_u32 vcc, 0, v15
    s_nop 0
    s_mov_b64 exec, vcc
    s_cbranch_execz L_X2r_3
    buffer_load_dwordx4 v[108:111], v22, s[52:55], s79 offen offset:2048 sc1
L_X2r_3:
    s_mov_b64 exec, -1
    s_waitcnt vmcnt(0)
    s_branch L_X2_b
L_X2_dead:
    s_mov_b32 s67, 0
    s_branch L_X2_c
L_X2_l0:
L_X2_l0b:
    s_sleep 22
    buffer_load_dwordx4 v[96:99], v22, s[52:55], 0 offen offset:2048 sc1
    buffer_load_dwordx4 v[100:103], v22, s[52:55], s77 offen offset:2048 sc1
    buffer_load_dwordx4 v[104:107], v22, s[52:55], s78 offen offset:2048 sc1
    buffer_load_dwordx4 v[108:111], v22, s[52:55], s79 offen offset:2048 sc1
    s_waitcnt vmcnt(0)
L_X2_k0:
    v_bitop3_b32 v16, v96, v97, v98 bitop3:0xfe
    v_bitop3_b32 v16, v16, v99, v100 bitop3:0xfe
    v_bitop3_b32 v16, v16, v101, v102 bitop3:0xfe
    v_bitop3_b32 v16, v16, v103, v104 bitop3:0xfe
    v_bitop3_b32 v16, v16, v105, v106 bitop3:0xfe
    v_bitop3_b32 v16, v16, v107, v108 bitop3:0xfe
    v_bitop3_b32 v16, v16, v109, v110 bitop3:0xfe
    v_bitop3_b32 v16, v16, v111, v111 bitop3:0xfe
    v_and_b32 v16, 1, v16
    v_cmp_ne_u32 vcc, 0, v16
    s_cbranch_vccz L_X2_ok0
    s_sub_u32 s67, s67, 1
    s_cbranch_scc1 L_X2_dead0
    v_or3_b32 v15, v96, v97, v98
    v_or_b32 v15, v15, v99
    v_and_b32 v15, 1, v15
    v_cmp_ne_u32 vcc, 0, v15
    s_sleep 1
    s_mov_b64 exec, vcc
    s_cbranch_execz L_X2r0_0
    buffer_load_dwordx4 v[96:99], v22, s[52:55], 0 offen offset:2048 sc1
L_X2r0_0:
    s_mov_b64 exec, -1
    v_or3_b32 v15, v100, v101, v102
    v_or_b32 v15, v15, v103
    v_and_b32 v15, 1, v15
    v_cmp_ne_u32 vcc, 0, v15
    s_nop 0
    s_mov_b64 exec, vcc
    s_cbranch_execz L_X2r0_1
    buffer_load_dwordx4 v[100:103], v22, s[52:55], s77 offen offset:2048 sc1
L_X2r0_1:
    s_mov_b64 exec, -1
    v_or3_b32 v15, v104, v105, v106
    v_or_b32 v15, v15, v107
    v_and_b32 v15, 1, v15
    v_cmp_ne_u32 vcc, 0, v15
    s_nop 0
    s_mov_b64 exec, vcc
    s_cbranch_execz L_X2r0_2
    buffer_load_dwordx4 v[104:107], v22, s[52:55], s78 offen offset:2048 sc1
L_X2r0_2:
    s_mov_b64 exec, -1
    v_or3_b32 v15, v108, v109, v110
    v_or_b32 v15, v15, v111
    v_and_b32 v15, 1, v15
    v_cmp_ne_u32 vcc, 0, v15
    s_nop 0
    s_mov_b64 exec, vcc
    s_cbranch_execz L_X2r0_3
    buffer_load_dwordx4 v[108:111], v22, s[52:55], s79 offen offset:2048 sc1
L_X2r0_3:
    s_mov_b64 exec, -1
L_X2_w0:
    s_waitcnt vmcnt(0)
    s_branch L_X2_k0
L_X2_dead0:
    s_mov_b32 s67, 0
L_X2_ok0:
    s_branch L_X2_b
L_X2x_slow:
    buffer_store_dwordx2 v[218:219], v28, s[48:51], s63 offen offset:0 sc1
    s_branch L_X2x_back
L_X2s_slow:
    buffer_store_dword v236, v29, s[48:51], 0 offen offset:0 sc1
    s_branch L_X2s_back
L_end:
    s_endpgm
.section .rodata,"a"
.p2align 6
.amdhsa_kernel interleave_layers__sliding_block_cached__mixer_channel_mlp__decode_kernel
  .amdhsa_next_free_vgpr 436
  .amdhsa_next_free_sgpr 96
  .amdhsa_accum_offset 244
  .amdhsa_group_segment_fixed_size 0
  .amdhsa_kernarg_size 104
  .amdhsa_user_sgpr_count 2
  .amdhsa_user_sgpr_kernarg_segment_ptr 1
  .amdhsa_system_sgpr_workgroup_id_x 1
  .amdhsa_float_denorm_mode_32 3
.end_amdhsa_kernel
```
